```python
import torch

def _softmax(x, axis=-1):
    return torch.softmax(x, dim=axis)
def _gelu(x):
    return torch.nn.functional.gelu(x, approximate="tanh")
def _silu(x):
    return torch.nn.functional.silu(x)
def _sigmoid(x):
    return torch.sigmoid(x)
def _layernorm(x, axis=-1, eps=1e-5):
    m = x.mean(dim=axis, keepdim=True)
    v = x.var(dim=axis, keepdim=True, unbiased=False)
    return (x - m) / torch.sqrt(v + eps)
def _scatter_add(tgt, idx, src, axis=0):
    return tgt.clone().index_add_(axis, idx, src)
def _segment_sum(src, seg, n):
    out = torch.zeros((n,) + src.shape[1:], dtype=src.dtype)
    return out.index_add_(0, seg, src)
def _pad(x, pw):
    flat = tuple(v for pair in reversed(pw) for v in pair)
    return torch.nn.functional.pad(x, flat)

kernel_name = 'recurrent_scan__mha_block_cached__dense_activation_gelu__decode'

def setup_inputs():

    _w = (lambda a: (lambda t: t.to(torch.bfloat16) if t.is_floating_point() else t)(torch.as_tensor(a)))
    def _A_setup():
        B, Sq, D = 8, 1, 576
        H, Sk, Dh = 32, 4096, 128
        return {
            "x": _w((lambda *s: torch.randn(*s, dtype=torch.bfloat16) * 0.05)(B, Sq, D)),
            "k_cache": _w((lambda *s: torch.randn(*s, dtype=torch.bfloat16) * 3.2)(B, H, Sk, Dh)),
            "v_cache": _w((lambda *s: torch.randn(*s, dtype=torch.bfloat16) * 3.2)(B, H, Sk, Dh)),
            "wq": _w((lambda *s: torch.randn(*s, dtype=torch.bfloat16) * 3.2)(D, H * Dh) * (D ** -0.5)),
            "wo": _w((lambda *s: torch.randn(*s, dtype=torch.bfloat16) * 3.2)(H * Dh, D) * ((H * Dh) ** -0.5)),
        }
    _A_in = _A_setup()

    def _B_setup():
        B, S, D, F = 8, 1, 576, 4608
        return {
            "x": _w((lambda *s: torch.randn(*s, dtype=torch.bfloat16) * 0.05)(B, S, D)),
            "w1": _w((lambda *s: torch.randn(*s, dtype=torch.bfloat16) * 3.2)(D, F) * (D ** -0.5)),
            "b1": _w((lambda *s: torch.randn(*s, dtype=torch.bfloat16) * 3.2)(F) * 0.01),
            "w2": _w((lambda *s: torch.randn(*s, dtype=torch.bfloat16) * 0.4)(F, D) * (F ** -0.5)),
            "b2": _w((lambda *s: torch.randn(*s, dtype=torch.bfloat16) * 0.4)(D) * 0.01),
        }
    _B_in = _B_setup()

    return {
        "A_x": _A_in["x"],
        "A_k_cache": _A_in["k_cache"],
        "A_v_cache": _A_in["v_cache"],
        "A_wq": _A_in["wq"],
        "A_wo": _A_in["wo"],
        "B_x": _B_in["x"],
        "B_w1": _B_in["w1"],
        "B_b1": _B_in["b1"],
        "B_w2": _B_in["w2"],
        "B_b2": _B_in["b2"],
    }

def reference(A_x, A_k_cache, A_v_cache, A_wq, A_wo, B_x, B_w1, B_b1, B_w2, B_b2):
    def _A_ref(x, k_cache, v_cache, wq, wo):
        B, Sq, D = x.shape
        H, Dh = 32, 128
        q = (lambda x, *d: x.permute(*d))((x @ wq).reshape(B, Sq, H, Dh), 0, 2, 1, 3)
        scores = torch.einsum("bhqd,bhkd->bhqk", q, k_cache) * (Dh ** -0.5)
        p = _softmax(scores, axis=-1)
        o = torch.einsum("bhqk,bhkd->bhqd", p, v_cache)
        return (lambda x, *d: x.permute(*d))(o, 0, 2, 1, 3).reshape(B, Sq, H * Dh) @ wo

    def _B_ref(x, w1, b1, w2, b2):
        h = torch.einsum("bsd,df->bsf", x, w1) + b1
        h = _gelu(h)
        return torch.einsum("bsf,fd->bsd", h, w2) + b2

    x = A_x
    xn = _layernorm(x, axis=-1)
    s = _A_ref(xn, A_k_cache, A_v_cache, A_wq, A_wo)
    g = _silu(_B_ref(xn, B_w1, B_b1, B_w2, B_b2))
    return x + s * g
```

```asm
; @launch grid=(256,1,1) block=(512,1,1) lds=147456
.amdgcn_target "amdgcn-amd-amdhsa--gfx950"
.text
.p2align 12
.globl recurrent_scan__mha_block_cached__dense_activation_gelu__decode_kernel
.p2align 8
.type recurrent_scan__mha_block_cached__dense_activation_gelu__decode_kernel,@function
recurrent_scan__mha_block_cached__dense_activation_gelu__decode_kernel:
    s_load_dwordx8 s[24:31], s[0:1], 64
    s_load_dwordx2 s[32:33], s[0:1], 96
    s_load_dwordx16 s[8:23], s[0:1], 0
    s_cmpk_ge_u32 s2, 0x100
    s_cbranch_scc1 L_exit
    v_readfirstlane_b32 s3, v0
    v_lshlrev_b32 v4, 4, v0
    s_and_b32 s54, s2, 7
    s_lshr_b32 s34, s2, 5
    s_mov_b32 s51, 0x20000
    s_cmpk_ge_u32 s3, 0x100
    s_cbranch_scc1 L_mark
    s_lshr_b32 s55, s2, 3
    s_lshl_b32 s58, s54, 5
    s_add_u32 s58, s58, s55
    s_mulk_i32 s58, 20736
    s_movk_i32 s50, 20736
    s_waitcnt lgkmcnt(0)
    s_add_u32 s48, s24, s58
    s_addc_u32 s49, s25, 0
    buffer_load_dwordx4 v[128:131], v4, s[48:51], 0 offen
    s_movk_i32 s56, 4096
    buffer_load_dwordx4 v[128:131], v4, s[48:51], s56 offen
    s_movk_i32 s56, 8192
    buffer_load_dwordx4 v[128:131], v4, s[48:51], s56 offen
    s_movk_i32 s56, 12288
    buffer_load_dwordx4 v[128:131], v4, s[48:51], s56 offen
    s_movk_i32 s56, 16384
    buffer_load_dwordx4 v[128:131], v4, s[48:51], s56 offen
    s_movk_i32 s56, 20480
    buffer_load_dwordx4 v[128:131], v4, s[48:51], s56 offen
    s_branch L_stream
L_mark:
    v_mov_b32 v56, -1
    v_mov_b32 v57, -1
    v_mov_b32 v58, -1
    v_mov_b32 v59, -1
    v_bfe_u32 v60, v4, 0, 12
    s_lshl3_add_u32 s55, s34, s54
    s_lshl_b32 s55, s55, 12
    s_mov_b32 s50, 835584
    s_and_b32 s54, s2, 24
    s_cbranch_scc1 L_helper
    s_waitcnt lgkmcnt(0)
    s_mov_b64 s[48:49], s[32:33]
L_mark_loop:
    buffer_store_dwordx4 v[56:59], v60, s[48:51], s55 offen sc1
    s_add_u32 s55, s55, 0x40000
    s_cmp_lt_u32 s55, s50
    s_cbranch_scc1 L_mark_loop
    s_branch L_helper
L_stream:
    s_setprio 3
    v_and_b32 v0, 63, v0
    s_lshr_b32 s3, s3, 6
    s_and_b32 s4, s3, 3
    s_bfe_u32 s35, s2, 65536
    s_bfe_u32 s5, s2, 65539
    s_lshl_b32 s5, s5, 1
    s_or_b32 s35, s35, s5
    s_bfe_u32 s5, s2, 131073
    s_lshl_b32 s5, s5, 2
    s_or_b32 s35, s35, s5
    s_bfe_u32 s5, s2, 65540
    s_lshl_b32 s5, s5, 4
    s_or_b32 s35, s35, s5
    s_and_b32 s5, s2, 0xe0
    s_or_b32 s5, s5, s35
    s_lshl_b32 s59, s4, 12
    v_lshlrev_b32 v1, 4, v0
    v_add_u32 v1, s59, v1
    s_lshl_b32 s59, s4, 15
    s_add_u32 m0, s59, 16384
    v_lshlrev_b32 v5, 4, v0
    s_mul_i32 s59, s4, 9216
    v_add_u32 v5, s59, v5
    v_lshrrev_b32 v6, 3, v0
    v_mul_u32_u24 v6, 9216, v6
    v_and_b32 v7, 7, v0
    v_lshl_add_u32 v6, v7, 4, v6
    s_lshl_b32 s59, s59, 3
    s_add_u32 s59, s59, 1024
    v_add_u32 v6, s59, v6
    v_and_b32 v7, 15, v0
    v_lshlrev_b32 v7, 4, v7
    v_bfe_u32 v8, v0, 4, 1
    v_lshl_add_u32 v7, v8, 9, v7
    v_bfe_u32 v8, v0, 5, 1
    v_lshl_add_u32 v7, v8, 12, v7
    s_lshl_b32 s59, s4, 13
    v_add_u32 v7, s59, v7
    s_and_b32 s59, s35, 13
    s_lshl_b32 s59, s59, 8
    s_mul_i32 s58, s55, 147456
    s_add_u32 s58, s58, s59
    s_add_u32 s40, s14, s58
    s_addc_u32 s41, s15, 0
    s_and_b32 s41, s41, 0xffff
    s_mov_b32 s42, 0
    s_mov_b32 s43, 0x20000
    s_sub_u32 s42, 147456, s59
    s_lshl_b32 s58, s35, 3
    s_add_u32 s58, s58, s34
    s_mul_i32 s58, s58, 18432
    s_add_u32 s44, s16, s58
    s_addc_u32 s45, s17, 0
    s_and_b32 s45, s45, 0xffff
    s_mov_b32 s46, 18432
    s_mov_b32 s47, 0x20000
    s_mul_i32 s58, s55, 165888
    s_mul_i32 s59, s54, 1152
    s_add_u32 s58, s58, s59
    s_add_u32 s36, s20, s58
    s_addc_u32 s37, s21, 0
    s_and_b32 s37, s37, 0xffff
    s_mov_b32 s38, 157824
    s_mov_b32 s39, 0x20000
    s_waitcnt vmcnt(4)
    buffer_load_dwordx4 v[128:131], v7, s[40:43], 0 offen
    s_waitcnt vmcnt(4)
    s_mov_b32 s56, 32768
    buffer_load_dwordx4 v[128:131], v7, s[40:43], s56 offen
    s_waitcnt vmcnt(4)
    s_mov_b32 s56, 65536
    buffer_load_dwordx4 v[128:131], v7, s[40:43], s56 offen
    s_waitcnt vmcnt(4)
    s_mov_b32 s56, 98304
    buffer_load_dwordx4 v[128:131], v7, s[40:43], s56 offen
    s_waitcnt vmcnt(4)
    s_mov_b32 s56, 131072
    buffer_load_dwordx4 v[128:131], v7, s[40:43], s56 offen
    s_waitcnt vmcnt(4)
    buffer_load_dwordx4 v[128:131], v4, s[44:47], 0 offen
    s_waitcnt vmcnt(4)
    s_mov_b32 s56, 4096
    buffer_load_dwordx4 v[128:131], v4, s[44:47], s56 offen
    s_waitcnt vmcnt(4)
    s_mov_b32 s56, 8192
    buffer_load_dwordx4 v[128:131], v4, s[44:47], s56 offen
    s_waitcnt vmcnt(4)
    s_mov_b32 s56, 12288
    buffer_load_dwordx4 v[128:131], v4, s[44:47], s56 offen
    s_waitcnt vmcnt(4)
    s_mov_b32 s56, 16384
    buffer_load_dwordx4 v[128:131], v4, s[44:47], s56 offen
    s_waitcnt vmcnt(4)
    buffer_load_dwordx4 v[128:131], v6, s[36:39], 0 offen
    s_waitcnt vmcnt(4)
    buffer_load_dwordx4 v[128:131], v5, s[36:39], 0 offen
    s_waitcnt vmcnt(4)
    s_mov_b32 s56, 36864
    buffer_load_dwordx4 v[128:131], v5, s[36:39], s56 offen
    s_waitcnt vmcnt(4)
    s_mov_b32 s56, 73728
    buffer_load_dwordx4 v[128:131], v5, s[36:39], s56 offen
    s_waitcnt vmcnt(4)
    s_mov_b32 s56, 110592
    buffer_load_dwordx4 v[128:131], v5, s[36:39], s56 offen
    s_waitcnt vmcnt(4)
    s_mov_b32 s56, 147456
    buffer_load_dwordx4 v[128:131], v5, s[36:39], s56 offen
    s_lshl_b32 s58, s5, 20
    s_add_u32 s36, s10, s58
    s_addc_u32 s37, s11, 0
    s_and_b32 s37, s37, 0xffff
    s_mov_b32 s38, 1048576
    s_mov_b32 s39, 0x20000
    s_mov_b32 s71, 0
    s_bfe_u32 s6, s5, 65536
    s_lshl_b32 s6, s6, 19
    s_xor_b32 s71, s71, s6
    s_bfe_u32 s6, s5, 65539
    s_lshl_b32 s6, s6, 18
    s_xor_b32 s71, s71, s6
    s_mov_b32 s70, 917504
    s_xor_b32 s6, s70, s71
    s_xor_b32 s7, s6, 16384
    s_mov_b32 s56, s6
    s_waitcnt vmcnt(4)
    buffer_load_dwordx4 v1, s[36:39], s56 offen offset:0 nt lds
    s_waitcnt vmcnt(4)
    buffer_load_dwordx4 v1, s[36:39], s56 offen offset:1024 nt lds
    s_waitcnt vmcnt(4)
    buffer_load_dwordx4 v1, s[36:39], s56 offen offset:2048 nt lds
    s_waitcnt vmcnt(4)
    buffer_load_dwordx4 v1, s[36:39], s56 offen offset:3072 nt lds
    s_add_u32 m0, m0, 4096
    s_add_u32 s56, s6, 65536
    s_waitcnt vmcnt(4)
    buffer_load_dwordx4 v1, s[36:39], s56 offen offset:0 nt lds
    s_add_u32 s40, s12, s58
    s_addc_u32 s41, s13, 0
    s_and_b32 s41, s41, 0xffff
    s_mov_b32 s42, 1048576
    s_mov_b32 s43, 0x20000
    v_and_b32 v26, 1, v0
    v_lshlrev_b32 v26, 4, v26
    v_mov_b32 v27, 0xffff
    v_lshlrev_b32 v26, v26, v27
    v_bfe_u32 v27, v0, 1, 2
    v_cmp_eq_u32 vcc, 0, v27
    s_nop 1
    v_cndmask_b32 v8, 0, v26, vcc
    v_cmp_eq_u32 vcc, 1, v27
    s_nop 1
    v_cndmask_b32 v9, 0, v26, vcc
    v_cmp_eq_u32 vcc, 2, v27
    s_nop 1
    v_cndmask_b32 v10, 0, v26, vcc
    v_cmp_eq_u32 vcc, 3, v27
    s_nop 1
    v_cndmask_b32 v11, 0, v26, vcc
    s_mov_b32 s62, 0xaaaaaaaa
    s_mov_b32 s63, 0xaaaaaaaa
    s_mov_b32 s64, 0xcccccccc
    s_mov_b32 s65, 0xcccccccc
    v_and_b32 v2, 15, v0
    v_lshlrev_b32 v2, 5, v2
    v_mov_b32 v32, 0
    v_mov_b32 v33, 0
    v_mov_b32 v34, 0
    v_mov_b32 v35, 0
    v_mov_b32 v36, 0
    v_mov_b32 v37, 0
    v_mov_b32 v38, 0
    v_mov_b32 v39, 0
    v_mov_b32 v109, 3360
    v_sub_u32 v104, 1, v0
    v_max_i32 v104, 0, v104
    s_mov_b32 s52, 0
    s_mov_b32 s53, 2
    s_waitcnt vmcnt(4)
    buffer_load_dwordx4 v1, s[36:39], s56 offen offset:1024 nt lds
    s_waitcnt vmcnt(4)
    buffer_load_dwordx4 v1, s[36:39], s56 offen offset:2048 nt lds
    s_waitcnt vmcnt(4)
    buffer_load_dwordx4 v1, s[36:39], s56 offen offset:3072 nt lds
    s_add_u32 m0, m0, 4096
    s_add_u32 s56, s6, 32768
    s_waitcnt vmcnt(4)
    buffer_load_dwordx4 v1, s[36:39], s56 offen offset:0 nt lds
    s_waitcnt vmcnt(4)
    buffer_load_dwordx4 v1, s[36:39], s56 offen offset:1024 nt lds
    s_waitcnt vmcnt(4)
    buffer_load_dwordx4 v1, s[36:39], s56 offen offset:2048 nt lds
    s_waitcnt vmcnt(4)
    buffer_load_dwordx4 v1, s[36:39], s56 offen offset:3072 nt lds
    s_add_u32 m0, m0, 4096
    s_add_u32 s56, s6, 98304
    s_waitcnt vmcnt(5)
    buffer_load_dwordx4 v1, s[36:39], s56 offen offset:0 nt lds
    s_waitcnt vmcnt(5)
    buffer_load_dwordx4 v1, s[36:39], s56 offen offset:1024 nt lds
    s_waitcnt vmcnt(5)
    buffer_load_dwordx4 v1, s[36:39], s56 offen offset:2048 nt lds
    s_waitcnt vmcnt(5)
    buffer_load_dwordx4 v1, s[36:39], s56 offen offset:3072 nt lds
    s_add_u32 m0, m0, 4096
    s_add_u32 s56, s7, 0
    s_waitcnt vmcnt(4)
    buffer_load_dwordx4 v1, s[36:39], s56 offen offset:0 nt lds
    s_waitcnt vmcnt(4)
    buffer_load_dwordx4 v1, s[36:39], s56 offen offset:1024 nt lds
    s_waitcnt vmcnt(4)
    buffer_load_dwordx4 v1, s[36:39], s56 offen offset:2048 nt lds
    s_waitcnt vmcnt(4)
    buffer_load_dwordx4 v1, s[36:39], s56 offen offset:3072 nt lds
    s_add_u32 m0, m0, 4096
    s_add_u32 s56, s7, 65536
    s_waitcnt vmcnt(4)
    buffer_load_dwordx4 v1, s[36:39], s56 offen offset:0 nt lds
    s_waitcnt vmcnt(4)
    buffer_load_dwordx4 v1, s[36:39], s56 offen offset:1024 nt lds
    s_waitcnt vmcnt(4)
    buffer_load_dwordx4 v1, s[36:39], s56 offen offset:2048 nt lds
    s_waitcnt vmcnt(4)
    buffer_load_dwordx4 v1, s[36:39], s56 offen offset:3072 nt lds
    s_add_u32 m0, m0, 4096
    s_add_u32 s56, s7, 32768
    s_waitcnt vmcnt(4)
    buffer_load_dwordx4 v1, s[36:39], s56 offen offset:0 nt lds
    s_waitcnt vmcnt(4)
    buffer_load_dwordx4 v1, s[36:39], s56 offen offset:1024 nt lds
    s_waitcnt vmcnt(4)
    buffer_load_dwordx4 v1, s[36:39], s56 offen offset:2048 nt lds
    s_waitcnt vmcnt(4)
    buffer_load_dwordx4 v1, s[36:39], s56 offen offset:3072 nt lds
    s_add_u32 m0, m0, 4096
    s_add_u32 s56, s7, 98304
    s_waitcnt vmcnt(5)
    buffer_load_dwordx4 v1, s[36:39], s56 offen offset:0 nt lds
    s_waitcnt vmcnt(5)
    buffer_load_dwordx4 v1, s[36:39], s56 offen offset:1024 nt lds
    s_waitcnt vmcnt(5)
    buffer_load_dwordx4 v1, s[36:39], s56 offen offset:2048 nt lds
    s_waitcnt vmcnt(5)
    buffer_load_dwordx4 v1, s[36:39], s56 offen offset:3072 nt lds
    s_add_u32 m0, m0, 4096
    s_mov_b32 s70, 0
    s_xor_b32 s6, s70, s71
    s_xor_b32 s7, s6, 16384
    s_mov_b32 s56, s6
    s_waitcnt vmcnt(4)
    buffer_load_dwordx4 v[128:131], v1, s[36:39], s56 offen offset:0 nt
    s_waitcnt vmcnt(4)
    buffer_load_dwordx4 v[132:135], v1, s[36:39], s56 offen offset:1024 nt
    s_waitcnt vmcnt(4)
    buffer_load_dwordx4 v[136:139], v1, s[36:39], s56 offen offset:2048 nt
    s_waitcnt vmcnt(4)
    buffer_load_dwordx4 v[140:143], v1, s[36:39], s56 offen offset:3072 nt
    s_add_u32 s56, s6, 65536
    s_waitcnt vmcnt(4)
    buffer_load_dwordx4 v[144:147], v1, s[36:39], s56 offen offset:0 nt
    s_waitcnt vmcnt(4)
    buffer_load_dwordx4 v[148:151], v1, s[36:39], s56 offen offset:1024 nt
    s_waitcnt vmcnt(4)
    buffer_load_dwordx4 v[152:155], v1, s[36:39], s56 offen offset:2048 nt
    s_waitcnt vmcnt(4)
    buffer_load_dwordx4 v[156:159], v1, s[36:39], s56 offen offset:3072 nt
    s_add_u32 s56, s6, 32768
    s_waitcnt vmcnt(4)
    buffer_load_dwordx4 v[160:163], v1, s[36:39], s56 offen offset:0 nt
    s_waitcnt vmcnt(4)
    buffer_load_dwordx4 v[164:167], v1, s[36:39], s56 offen offset:1024 nt
    s_waitcnt vmcnt(4)
    buffer_load_dwordx4 v[168:171], v1, s[36:39], s56 offen offset:2048 nt
    s_waitcnt vmcnt(4)
    buffer_load_dwordx4 v[172:175], v1, s[36:39], s56 offen offset:3072 nt
    s_add_u32 s56, s6, 98304
    s_waitcnt vmcnt(5)
    buffer_load_dwordx4 v[176:179], v1, s[36:39], s56 offen offset:0 nt
    s_waitcnt vmcnt(5)
    buffer_load_dwordx4 v[180:183], v1, s[36:39], s56 offen offset:1024 nt
    s_waitcnt vmcnt(5)
    buffer_load_dwordx4 v[184:187], v1, s[36:39], s56 offen offset:2048 nt
    s_waitcnt vmcnt(5)
    buffer_load_dwordx4 v[188:191], v1, s[36:39], s56 offen offset:3072 nt
    s_add_u32 s56, s7, 0
    s_waitcnt vmcnt(4)
    buffer_load_dwordx4 v[192:195], v1, s[36:39], s56 offen offset:0 nt
    s_waitcnt vmcnt(4)
    buffer_load_dwordx4 v[196:199], v1, s[36:39], s56 offen offset:1024 nt
    s_waitcnt vmcnt(4)
    buffer_load_dwordx4 v[200:203], v1, s[36:39], s56 offen offset:2048 nt
    s_waitcnt vmcnt(4)
    buffer_load_dwordx4 v[204:207], v1, s[36:39], s56 offen offset:3072 nt
    s_add_u32 s56, s7, 65536
    s_waitcnt vmcnt(4)
    buffer_load_dwordx4 v[208:211], v1, s[36:39], s56 offen offset:0 nt
    s_waitcnt vmcnt(4)
    buffer_load_dwordx4 v[212:215], v1, s[36:39], s56 offen offset:1024 nt
    s_waitcnt vmcnt(4)
    buffer_load_dwordx4 v[216:219], v1, s[36:39], s56 offen offset:2048 nt
    s_waitcnt vmcnt(4)
    buffer_load_dwordx4 v[220:223], v1, s[36:39], s56 offen offset:3072 nt
    s_add_u32 s56, s7, 32768
    s_waitcnt vmcnt(4)
    buffer_load_dwordx4 v[224:227], v1, s[36:39], s56 offen offset:0 nt
    s_waitcnt vmcnt(4)
    buffer_load_dwordx4 v[228:231], v1, s[36:39], s56 offen offset:1024 nt
    s_waitcnt vmcnt(4)
    buffer_load_dwordx4 v[232:235], v1, s[36:39], s56 offen offset:2048 nt
    s_waitcnt vmcnt(4)
    buffer_load_dwordx4 v[236:239], v1, s[36:39], s56 offen offset:3072 nt
    s_add_u32 s56, s7, 98304
    s_waitcnt vmcnt(5)
    buffer_load_dwordx4 v[240:243], v1, s[36:39], s56 offen offset:0 nt
    s_waitcnt vmcnt(5)
    buffer_load_dwordx4 v[244:247], v1, s[36:39], s56 offen offset:1024 nt
    s_waitcnt vmcnt(6)
    buffer_load_dwordx4 v[248:251], v1, s[36:39], s56 offen offset:2048 nt
    s_waitcnt vmcnt(6)
    buffer_load_dwordx4 v[252:255], v1, s[36:39], s56 offen offset:3072 nt
    s_add_u32 s70, s70, 131072
    s_xor_b32 s6, s70, s71
    s_xor_b32 s7, s6, 16384
    s_add_u32 s56, s6, 0
    s_barrier
    ds_read_b128 v[40:43], v2 offset:0
    ds_read_b128 v[44:47], v2 offset:16
    ds_read_b128 v[48:51], v2 offset:512
    ds_read_b128 v[52:55], v2 offset:528
    ds_read_b128 v[56:59], v2 offset:1024
    ds_read_b128 v[60:63], v2 offset:1040
    ds_read_b128 v[64:67], v2 offset:1536
    ds_read_b128 v[68:71], v2 offset:1552
    s_waitcnt lgkmcnt(0)
    v_add_f32 v40, v40, v48
    v_add_f32 v56, v56, v64
    v_add_f32 v41, v41, v49
    v_add_f32 v57, v57, v65
    v_add_f32 v42, v42, v50
    v_add_f32 v58, v58, v66
    v_add_f32 v43, v43, v51
    v_add_f32 v59, v59, v67
    v_add_f32 v44, v44, v52
    v_add_f32 v60, v60, v68
    v_add_f32 v45, v45, v53
    v_add_f32 v61, v61, v69
    v_add_f32 v46, v46, v54
    v_add_f32 v62, v62, v70
    v_add_f32 v47, v47, v55
    v_add_f32 v63, v63, v71
    v_add_f32 v40, v40, v56
    v_add_f32 v41, v41, v57
    v_add_f32 v42, v42, v58
    v_add_f32 v43, v43, v59
    v_add_f32 v44, v44, v60
    v_add_f32 v45, v45, v61
    v_add_f32 v46, v46, v62
    v_add_f32 v47, v47, v63
    v_cvt_pk_bf16_f32 v4, v40, v41
    v_cvt_pk_bf16_f32 v5, v42, v43
    v_cvt_pk_bf16_f32 v6, v44, v45
    v_cvt_pk_bf16_f32 v7, v46, v47
    s_mov_b32 s57, 6
L_k:
    ds_add_rtn_u32 v106, v109, v104 offset:4
    s_bitcmp1_b32 s52, 14
    s_cbranch_scc1 L_bo1
    s_waitcnt vmcnt(4)
L_bo1:
    s_waitcnt vmcnt(6)
    v_dot2_f32_bf16 v40, v128, v4, 0
    v_dot2_f32_bf16 v40, v129, v5, v40
    v_dot2_f32_bf16 v40, v130, v6, v40
    v_dot2_f32_bf16 v40, v131, v7, v40
    buffer_load_dwordx4 v[128:131], v1, s[36:39], s56 offen offset:0 nt
    ds_read_b32 v105, v109 offset:8
    s_bitcmp1_b32 s52, 15
    s_cbranch_scc1 L_bo2
    s_waitcnt vmcnt(4)
L_bo2:
    s_waitcnt vmcnt(6)
    v_dot2_f32_bf16 v41, v132, v4, 0
    v_dot2_f32_bf16 v41, v133, v5, v41
    v_dot2_f32_bf16 v41, v134, v6, v41
    v_dot2_f32_bf16 v41, v135, v7, v41
    buffer_load_dwordx4 v[132:135], v1, s[36:39], s56 offen offset:1024 nt
    s_waitcnt lgkmcnt(0)
    v_readfirstlane_b32 s52, v105
    v_readfirstlane_b32 s60, v106
    s_add_u32 s52, s52, 1
    s_lshr_b32 s52, s52, 1
    s_sub_i32 s60, s60, s53
    s_add_u32 s53, s53, 16
    s_max_i32 s60, s60, 0
    s_mul_i32 s60, s60, 3
    s_add_u32 s52, s52, s60
    s_min_u32 s52, s52, 16
    s_bfm_b32 s52, s52, 0
    s_bitcmp1_b32 s52, 0
    s_cbranch_scc1 L_bo3
    s_waitcnt vmcnt(4)
L_bo3:
    s_waitcnt vmcnt(6)
    v_dot2_f32_bf16 v42, v136, v4, 0
    v_dot2_f32_bf16 v42, v137, v5, v42
    v_dot2_f32_bf16 v42, v138, v6, v42
    v_dot2_f32_bf16 v42, v139, v7, v42
    buffer_load_dwordx4 v[136:139], v1, s[36:39], s56 offen offset:2048 nt
    s_bitcmp1_b32 s52, 1
    s_cbranch_scc1 L_bo4
    s_waitcnt vmcnt(4)
L_bo4:
    s_waitcnt vmcnt(6)
    v_dot2_f32_bf16 v43, v140, v4, 0
    v_dot2_f32_bf16 v43, v141, v5, v43
    v_dot2_f32_bf16 v43, v142, v6, v43
    v_dot2_f32_bf16 v43, v143, v7, v43
    buffer_load_dwordx4 v[140:143], v1, s[36:39], s56 offen offset:3072 nt
    s_add_u32 s56, s6, 65536
    ds_add_u32 v109, v104 offset:4
    s_bitcmp1_b32 s52, 2
    s_cbranch_scc1 L_bo5
    s_waitcnt vmcnt(4)
L_bo5:
    s_waitcnt vmcnt(6)
    v_dot2_f32_bf16 v44, v144, v4, 0
    v_dot2_f32_bf16 v44, v145, v5, v44
    v_dot2_f32_bf16 v44, v146, v6, v44
    v_dot2_f32_bf16 v44, v147, v7, v44
    buffer_load_dwordx4 v[144:147], v1, s[36:39], s56 offen offset:0 nt
    s_bitcmp1_b32 s52, 3
    s_cbranch_scc1 L_bo6
    s_waitcnt vmcnt(4)
L_bo6:
    s_waitcnt vmcnt(6)
    v_dot2_f32_bf16 v45, v148, v4, 0
    v_dot2_f32_bf16 v45, v149, v5, v45
    v_dot2_f32_bf16 v45, v150, v6, v45
    v_dot2_f32_bf16 v45, v151, v7, v45
    buffer_load_dwordx4 v[148:151], v1, s[36:39], s56 offen offset:1024 nt
    s_bitcmp1_b32 s52, 4
    s_cbranch_scc1 L_bo7
    s_waitcnt vmcnt(4)
L_bo7:
    s_waitcnt vmcnt(6)
    v_dot2_f32_bf16 v46, v152, v4, 0
    v_dot2_f32_bf16 v46, v153, v5, v46
    v_dot2_f32_bf16 v46, v154, v6, v46
    v_dot2_f32_bf16 v46, v155, v7, v46
    buffer_load_dwordx4 v[152:155], v1, s[36:39], s56 offen offset:2048 nt
    s_bitcmp1_b32 s52, 5
    s_cbranch_scc1 L_bo8
    s_waitcnt vmcnt(4)
L_bo8:
    s_waitcnt vmcnt(6)
    v_dot2_f32_bf16 v47, v156, v4, 0
    v_dot2_f32_bf16 v47, v157, v5, v47
    v_dot2_f32_bf16 v47, v158, v6, v47
    v_dot2_f32_bf16 v47, v159, v7, v47
    buffer_load_dwordx4 v[156:159], v1, s[36:39], s56 offen offset:3072 nt
    s_add_u32 s56, s6, 32768
    ds_add_u32 v109, v104 offset:4
    s_bitcmp1_b32 s52, 6
    s_cbranch_scc1 L_bo9
    s_waitcnt vmcnt(4)
L_bo9:
    s_waitcnt vmcnt(6)
    v_dot2_f32_bf16 v48, v160, v4, 0
    v_dot2_f32_bf16 v48, v161, v5, v48
    v_dot2_f32_bf16 v48, v162, v6, v48
    v_dot2_f32_bf16 v48, v163, v7, v48
    buffer_load_dwordx4 v[160:163], v1, s[36:39], s56 offen offset:0 nt
    s_bitcmp1_b32 s52, 7
    s_cbranch_scc1 L_bo10
    s_waitcnt vmcnt(4)
L_bo10:
    s_waitcnt vmcnt(6)
    v_dot2_f32_bf16 v49, v164, v4, 0
    v_dot2_f32_bf16 v49, v165, v5, v49
    v_dot2_f32_bf16 v49, v166, v6, v49
    v_dot2_f32_bf16 v49, v167, v7, v49
    buffer_load_dwordx4 v[164:167], v1, s[36:39], s56 offen offset:1024 nt
    s_bitcmp1_b32 s52, 8
    s_cbranch_scc1 L_bo11
    s_waitcnt vmcnt(4)
L_bo11:
    s_waitcnt vmcnt(6)
    v_dot2_f32_bf16 v50, v168, v4, 0
    v_dot2_f32_bf16 v50, v169, v5, v50
    v_dot2_f32_bf16 v50, v170, v6, v50
    v_dot2_f32_bf16 v50, v171, v7, v50
    buffer_load_dwordx4 v[168:171], v1, s[36:39], s56 offen offset:2048 nt
    s_bitcmp1_b32 s52, 9
    s_cbranch_scc1 L_bo12
    s_waitcnt vmcnt(4)
L_bo12:
    s_waitcnt vmcnt(6)
    v_dot2_f32_bf16 v51, v172, v4, 0
    v_dot2_f32_bf16 v51, v173, v5, v51
    v_dot2_f32_bf16 v51, v174, v6, v51
    v_dot2_f32_bf16 v51, v175, v7, v51
    buffer_load_dwordx4 v[172:175], v1, s[36:39], s56 offen offset:3072 nt
    s_add_u32 s56, s6, 98304
    ds_add_u32 v109, v104 offset:4
    s_bitcmp1_b32 s52, 10
    s_cbranch_scc1 L_bo13
    s_waitcnt vmcnt(4)
L_bo13:
    s_waitcnt vmcnt(6)
    v_dot2_f32_bf16 v52, v176, v4, 0
    v_dot2_f32_bf16 v52, v177, v5, v52
    v_dot2_f32_bf16 v52, v178, v6, v52
    v_dot2_f32_bf16 v52, v179, v7, v52
    buffer_load_dwordx4 v[176:179], v1, s[36:39], s56 offen offset:0 nt
    s_bitcmp1_b32 s52, 11
    s_cbranch_scc1 L_bo14
    s_waitcnt vmcnt(4)
L_bo14:
    s_waitcnt vmcnt(6)
    v_dot2_f32_bf16 v53, v180, v4, 0
    v_dot2_f32_bf16 v53, v181, v5, v53
    v_dot2_f32_bf16 v53, v182, v6, v53
    v_dot2_f32_bf16 v53, v183, v7, v53
    buffer_load_dwordx4 v[180:183], v1, s[36:39], s56 offen offset:1024 nt
    s_bitcmp1_b32 s52, 12
    s_cbranch_scc1 L_bo15
    s_waitcnt vmcnt(4)
L_bo15:
    s_waitcnt vmcnt(6)
    v_dot2_f32_bf16 v54, v184, v4, 0
    v_dot2_f32_bf16 v54, v185, v5, v54
    v_dot2_f32_bf16 v54, v186, v6, v54
    v_dot2_f32_bf16 v54, v187, v7, v54
    buffer_load_dwordx4 v[184:187], v1, s[36:39], s56 offen offset:2048 nt
    s_bitcmp1_b32 s52, 13
    s_cbranch_scc1 L_bo16
    s_waitcnt vmcnt(5)
L_bo16:
    s_waitcnt vmcnt(7)
    v_dot2_f32_bf16 v55, v188, v4, 0
    v_dot2_f32_bf16 v55, v189, v5, v55
    v_dot2_f32_bf16 v55, v190, v6, v55
    v_dot2_f32_bf16 v55, v191, v7, v55
    buffer_load_dwordx4 v[188:191], v1, s[36:39], s56 offen offset:3072 nt
    s_add_u32 s56, s7, 0
    v_add_f32_dpp v40, v40, v40 row_ror:8 row_mask:0xf bank_mask:0x3
    v_add_f32_dpp v40, v41, v41 row_ror:8 row_mask:0xf bank_mask:0xc
    v_add_f32_dpp v42, v42, v42 row_ror:8 row_mask:0xf bank_mask:0x3
    v_add_f32_dpp v42, v43, v43 row_ror:8 row_mask:0xf bank_mask:0xc
    v_add_f32_dpp v44, v44, v44 row_ror:8 row_mask:0xf bank_mask:0x3
    v_add_f32_dpp v44, v45, v45 row_ror:8 row_mask:0xf bank_mask:0xc
    v_add_f32_dpp v46, v46, v46 row_ror:8 row_mask:0xf bank_mask:0x3
    v_add_f32_dpp v46, v47, v47 row_ror:8 row_mask:0xf bank_mask:0xc
    v_add_f32_dpp v48, v48, v48 row_ror:8 row_mask:0xf bank_mask:0x3
    v_add_f32_dpp v48, v49, v49 row_ror:8 row_mask:0xf bank_mask:0xc
    v_add_f32_dpp v50, v50, v50 row_ror:8 row_mask:0xf bank_mask:0x3
    v_add_f32_dpp v50, v51, v51 row_ror:8 row_mask:0xf bank_mask:0xc
    v_add_f32_dpp v52, v52, v52 row_ror:8 row_mask:0xf bank_mask:0x3
    v_add_f32_dpp v52, v53, v53 row_ror:8 row_mask:0xf bank_mask:0xc
    v_add_f32_dpp v54, v54, v54 row_ror:8 row_mask:0xf bank_mask:0x3
    v_add_f32_dpp v54, v55, v55 row_ror:8 row_mask:0xf bank_mask:0xc
    v_add_f32_dpp v40, v40, v40 row_shl:4 row_mask:0xf bank_mask:0x5
    v_add_f32_dpp v40, v42, v42 row_shr:4 row_mask:0xf bank_mask:0xa
    v_add_f32_dpp v44, v44, v44 row_shl:4 row_mask:0xf bank_mask:0x5
    v_add_f32_dpp v44, v46, v46 row_shr:4 row_mask:0xf bank_mask:0xa
    v_add_f32_dpp v48, v48, v48 row_shl:4 row_mask:0xf bank_mask:0x5
    v_add_f32_dpp v48, v50, v50 row_shr:4 row_mask:0xf bank_mask:0xa
    v_add_f32_dpp v52, v52, v52 row_shl:4 row_mask:0xf bank_mask:0x5
    v_add_f32_dpp v52, v54, v54 row_shr:4 row_mask:0xf bank_mask:0xa
    v_add_f32_dpp v40, v40, v40 quad_perm:[1,0,3,2] row_mask:0xf bank_mask:0xf
    v_add_f32_dpp v44, v44, v44 quad_perm:[1,0,3,2] row_mask:0xf bank_mask:0xf
    v_add_f32_dpp v48, v48, v48 quad_perm:[1,0,3,2] row_mask:0xf bank_mask:0xf
    v_add_f32_dpp v52, v52, v52 quad_perm:[1,0,3,2] row_mask:0xf bank_mask:0xf
    v_cndmask_b32 v40, v40, v44, s[62:63]
    v_cndmask_b32 v48, v48, v52, s[62:63]
    s_nop 0
    v_add_f32_dpp v40, v40, v40 quad_perm:[2,3,0,1] row_mask:0xf bank_mask:0xf
    v_add_f32_dpp v48, v48, v48 quad_perm:[2,3,0,1] row_mask:0xf bank_mask:0xf
    v_cndmask_b32 v27, v40, v48, s[64:65]
    ds_add_rtn_u32 v106, v109, v104 offset:4
    s_bitcmp1_b32 s52, 14
    s_cbranch_scc1 L_bo17
    s_waitcnt vmcnt(4)
L_bo17:
    s_waitcnt vmcnt(6)
    v_dot2_f32_bf16 v40, v192, v4, 0
    v_dot2_f32_bf16 v40, v193, v5, v40
    v_dot2_f32_bf16 v40, v194, v6, v40
    v_dot2_f32_bf16 v40, v195, v7, v40
    buffer_load_dwordx4 v[192:195], v1, s[36:39], s56 offen offset:0 nt
    ds_read_b32 v105, v109 offset:8
    s_bitcmp1_b32 s52, 15
    s_cbranch_scc1 L_bo18
    s_waitcnt vmcnt(4)
L_bo18:
    s_waitcnt vmcnt(6)
    v_dot2_f32_bf16 v41, v196, v4, 0
    v_dot2_f32_bf16 v41, v197, v5, v41
    v_dot2_f32_bf16 v41, v198, v6, v41
    v_dot2_f32_bf16 v41, v199, v7, v41
    buffer_load_dwordx4 v[196:199], v1, s[36:39], s56 offen offset:1024 nt
    s_waitcnt lgkmcnt(0)
    v_readfirstlane_b32 s52, v105
    v_readfirstlane_b32 s60, v106
    s_lshr_b32 s52, s52, 1
    s_sub_i32 s60, s60, s53
    s_add_u32 s53, s53, 16
    s_max_i32 s60, s60, 0
    s_mul_i32 s60, s60, 3
    s_add_u32 s52, s52, s60
    s_min_u32 s52, s52, 16
    s_bfm_b32 s52, s52, 0
    s_bitcmp1_b32 s52, 0
    s_cbranch_scc1 L_bo19
    s_waitcnt vmcnt(4)
L_bo19:
    s_waitcnt vmcnt(6)
    v_dot2_f32_bf16 v42, v200, v4, 0
    v_dot2_f32_bf16 v42, v201, v5, v42
    v_dot2_f32_bf16 v42, v202, v6, v42
    v_dot2_f32_bf16 v42, v203, v7, v42
    buffer_load_dwordx4 v[200:203], v1, s[36:39], s56 offen offset:2048 nt
    s_bitcmp1_b32 s52, 1
    s_cbranch_scc1 L_bo20
    s_waitcnt vmcnt(4)
L_bo20:
    s_waitcnt vmcnt(6)
    v_dot2_f32_bf16 v43, v204, v4, 0
    v_dot2_f32_bf16 v43, v205, v5, v43
    v_dot2_f32_bf16 v43, v206, v6, v43
    v_dot2_f32_bf16 v43, v207, v7, v43
    buffer_load_dwordx4 v[204:207], v1, s[36:39], s56 offen offset:3072 nt
    s_add_u32 s56, s7, 65536
    ds_add_u32 v109, v104 offset:4
    s_bitcmp1_b32 s52, 2
    s_cbranch_scc1 L_bo21
    s_waitcnt vmcnt(4)
L_bo21:
    s_waitcnt vmcnt(6)
    v_dot2_f32_bf16 v44, v208, v4, 0
    v_dot2_f32_bf16 v44, v209, v5, v44
    v_dot2_f32_bf16 v44, v210, v6, v44
    v_dot2_f32_bf16 v44, v211, v7, v44
    buffer_load_dwordx4 v[208:211], v1, s[36:39], s56 offen offset:0 nt
    s_bitcmp1_b32 s52, 3
    s_cbranch_scc1 L_bo22
    s_waitcnt vmcnt(4)
L_bo22:
    s_waitcnt vmcnt(6)
    v_dot2_f32_bf16 v45, v212, v4, 0
    v_dot2_f32_bf16 v45, v213, v5, v45
    v_dot2_f32_bf16 v45, v214, v6, v45
    v_dot2_f32_bf16 v45, v215, v7, v45
    buffer_load_dwordx4 v[212:215], v1, s[36:39], s56 offen offset:1024 nt
    s_bitcmp1_b32 s52, 4
    s_cbranch_scc1 L_bo23
    s_waitcnt vmcnt(4)
L_bo23:
    s_waitcnt vmcnt(6)
    v_dot2_f32_bf16 v46, v216, v4, 0
    v_dot2_f32_bf16 v46, v217, v5, v46
    v_dot2_f32_bf16 v46, v218, v6, v46
    v_dot2_f32_bf16 v46, v219, v7, v46
    buffer_load_dwordx4 v[216:219], v1, s[36:39], s56 offen offset:2048 nt
    s_bitcmp1_b32 s52, 5
    s_cbranch_scc1 L_bo24
    s_waitcnt vmcnt(4)
L_bo24:
    s_waitcnt vmcnt(6)
    v_dot2_f32_bf16 v47, v220, v4, 0
    v_dot2_f32_bf16 v47, v221, v5, v47
    v_dot2_f32_bf16 v47, v222, v6, v47
    v_dot2_f32_bf16 v47, v223, v7, v47
    buffer_load_dwordx4 v[220:223], v1, s[36:39], s56 offen offset:3072 nt
    s_add_u32 s56, s7, 32768
    ds_add_u32 v109, v104 offset:4
    s_bitcmp1_b32 s52, 6
    s_cbranch_scc1 L_bo25
    s_waitcnt vmcnt(4)
L_bo25:
    s_waitcnt vmcnt(6)
    v_dot2_f32_bf16 v48, v224, v4, 0
    v_dot2_f32_bf16 v48, v225, v5, v48
    v_dot2_f32_bf16 v48, v226, v6, v48
    v_dot2_f32_bf16 v48, v227, v7, v48
    buffer_load_dwordx4 v[224:227], v1, s[36:39], s56 offen offset:0 nt
    s_bitcmp1_b32 s52, 7
    s_cbranch_scc1 L_bo26
    s_waitcnt vmcnt(4)
L_bo26:
    s_waitcnt vmcnt(6)
    v_dot2_f32_bf16 v49, v228, v4, 0
    v_dot2_f32_bf16 v49, v229, v5, v49
    v_dot2_f32_bf16 v49, v230, v6, v49
    v_dot2_f32_bf16 v49, v231, v7, v49
    buffer_load_dwordx4 v[228:231], v1, s[36:39], s56 offen offset:1024 nt
    s_bitcmp1_b32 s52, 8
    s_cbranch_scc1 L_bo27
    s_waitcnt vmcnt(4)
L_bo27:
    s_waitcnt vmcnt(6)
    v_dot2_f32_bf16 v50, v232, v4, 0
    v_dot2_f32_bf16 v50, v233, v5, v50
    v_dot2_f32_bf16 v50, v234, v6, v50
    v_dot2_f32_bf16 v50, v235, v7, v50
    buffer_load_dwordx4 v[232:235], v1, s[36:39], s56 offen offset:2048 nt
    s_bitcmp1_b32 s52, 9
    s_cbranch_scc1 L_bo28
    s_waitcnt vmcnt(4)
L_bo28:
    s_waitcnt vmcnt(6)
    v_dot2_f32_bf16 v51, v236, v4, 0
    v_dot2_f32_bf16 v51, v237, v5, v51
    v_dot2_f32_bf16 v51, v238, v6, v51
    v_dot2_f32_bf16 v51, v239, v7, v51
    buffer_load_dwordx4 v[236:239], v1, s[36:39], s56 offen offset:3072 nt
    s_add_u32 s56, s7, 98304
    ds_add_u32 v109, v104 offset:4
    s_bitcmp1_b32 s52, 10
    s_cbranch_scc1 L_bo29
    s_waitcnt vmcnt(4)
L_bo29:
    s_waitcnt vmcnt(6)
    v_dot2_f32_bf16 v52, v240, v4, 0
    v_dot2_f32_bf16 v52, v241, v5, v52
    v_dot2_f32_bf16 v52, v242, v6, v52
    v_dot2_f32_bf16 v52, v243, v7, v52
    buffer_load_dwordx4 v[240:243], v1, s[36:39], s56 offen offset:0 nt
    s_bitcmp1_b32 s52, 11
    s_cbranch_scc1 L_bo30
    s_waitcnt vmcnt(4)
L_bo30:
    s_waitcnt vmcnt(6)
    v_dot2_f32_bf16 v53, v244, v4, 0
    v_dot2_f32_bf16 v53, v245, v5, v53
    v_dot2_f32_bf16 v53, v246, v6, v53
    v_dot2_f32_bf16 v53, v247, v7, v53
    buffer_load_dwordx4 v[244:247], v1, s[36:39], s56 offen offset:1024 nt
    s_bitcmp1_b32 s52, 12
    s_cbranch_scc1 L_bo31
    s_waitcnt vmcnt(4)
L_bo31:
    s_waitcnt vmcnt(6)
    v_dot2_f32_bf16 v54, v248, v4, 0
    v_dot2_f32_bf16 v54, v249, v5, v54
    v_dot2_f32_bf16 v54, v250, v6, v54
    v_dot2_f32_bf16 v54, v251, v7, v54
    buffer_load_dwordx4 v[248:251], v1, s[36:39], s56 offen offset:2048 nt
    s_bitcmp1_b32 s52, 13
    s_cbranch_scc1 L_bo32
    s_waitcnt vmcnt(5)
L_bo32:
    s_waitcnt vmcnt(7)
    v_dot2_f32_bf16 v55, v252, v4, 0
    v_dot2_f32_bf16 v55, v253, v5, v55
    v_dot2_f32_bf16 v55, v254, v6, v55
    v_dot2_f32_bf16 v55, v255, v7, v55
    buffer_load_dwordx4 v[252:255], v1, s[36:39], s56 offen offset:3072 nt
    s_add_u32 s70, s70, 131072
    s_xor_b32 s6, s70, s71
    s_xor_b32 s7, s6, 16384
    s_add_u32 s56, s6, 0
    v_add_f32_dpp v40, v40, v40 row_ror:8 row_mask:0xf bank_mask:0x3
    v_add_f32_dpp v40, v41, v41 row_ror:8 row_mask:0xf bank_mask:0xc
    v_add_f32_dpp v42, v42, v42 row_ror:8 row_mask:0xf bank_mask:0x3
    v_add_f32_dpp v42, v43, v43 row_ror:8 row_mask:0xf bank_mask:0xc
    v_add_f32_dpp v44, v44, v44 row_ror:8 row_mask:0xf bank_mask:0x3
    v_add_f32_dpp v44, v45, v45 row_ror:8 row_mask:0xf bank_mask:0xc
    v_add_f32_dpp v46, v46, v46 row_ror:8 row_mask:0xf bank_mask:0x3
    v_add_f32_dpp v46, v47, v47 row_ror:8 row_mask:0xf bank_mask:0xc
    v_add_f32_dpp v48, v48, v48 row_ror:8 row_mask:0xf bank_mask:0x3
    v_add_f32_dpp v48, v49, v49 row_ror:8 row_mask:0xf bank_mask:0xc
    v_add_f32_dpp v50, v50, v50 row_ror:8 row_mask:0xf bank_mask:0x3
    v_add_f32_dpp v50, v51, v51 row_ror:8 row_mask:0xf bank_mask:0xc
    v_add_f32_dpp v52, v52, v52 row_ror:8 row_mask:0xf bank_mask:0x3
    v_add_f32_dpp v52, v53, v53 row_ror:8 row_mask:0xf bank_mask:0xc
    v_add_f32_dpp v54, v54, v54 row_ror:8 row_mask:0xf bank_mask:0x3
    v_add_f32_dpp v54, v55, v55 row_ror:8 row_mask:0xf bank_mask:0xc
    v_add_f32_dpp v40, v40, v40 row_shl:4 row_mask:0xf bank_mask:0x5
    v_add_f32_dpp v40, v42, v42 row_shr:4 row_mask:0xf bank_mask:0xa
    v_add_f32_dpp v44, v44, v44 row_shl:4 row_mask:0xf bank_mask:0x5
    v_add_f32_dpp v44, v46, v46 row_shr:4 row_mask:0xf bank_mask:0xa
    v_add_f32_dpp v48, v48, v48 row_shl:4 row_mask:0xf bank_mask:0x5
    v_add_f32_dpp v48, v50, v50 row_shr:4 row_mask:0xf bank_mask:0xa
    v_add_f32_dpp v52, v52, v52 row_shl:4 row_mask:0xf bank_mask:0x5
    v_add_f32_dpp v52, v54, v54 row_shr:4 row_mask:0xf bank_mask:0xa
    v_add_f32_dpp v40, v40, v40 quad_perm:[1,0,3,2] row_mask:0xf bank_mask:0xf
    v_add_f32_dpp v44, v44, v44 quad_perm:[1,0,3,2] row_mask:0xf bank_mask:0xf
    v_add_f32_dpp v48, v48, v48 quad_perm:[1,0,3,2] row_mask:0xf bank_mask:0xf
    v_add_f32_dpp v52, v52, v52 quad_perm:[1,0,3,2] row_mask:0xf bank_mask:0xf
    v_cndmask_b32 v40, v40, v44, s[62:63]
    v_cndmask_b32 v48, v48, v52, s[62:63]
    s_nop 0
    v_add_f32_dpp v40, v40, v40 quad_perm:[2,3,0,1] row_mask:0xf bank_mask:0xf
    v_add_f32_dpp v48, v48, v48 quad_perm:[2,3,0,1] row_mask:0xf bank_mask:0xf
    v_cndmask_b32 v40, v40, v48, s[64:65]
    v_cvt_pk_bf16_f32 v26, v27, v40
    v_lshlrev_b32 v27, 16, v26
    v_and_b32 v26, 0xffff0000, v26
    v_mul_f32 v27, 0x3db504f3, v27
    v_mul_f32 v26, 0x3db504f3, v26
    v_mov_b32 v32, v33
    v_mov_b32 v33, v34
    v_mov_b32 v34, v35
    v_mov_b32 v35, v36
    v_mov_b32 v36, v37
    v_mov_b32 v37, v38
    v_mov_b32 v38, v39
    v_cvt_pk_bf16_f32 v39, v27, v26
    s_sub_u32 s57, s57, 1
    s_cmp_lg_u32 s57, 0
    s_cbranch_scc1 L_k
    s_mov_b32 s70, 0
    s_xor_b32 s6, s70, s71
    s_xor_b32 s7, s6, 16384
    s_mov_b32 s56, s6
    s_lshl_b32 s59, s4, 15
    s_add_u32 s59, s59, 16384
    v_lshlrev_b32 v3, 4, v0
    v_add_u32 v3, s59, v3
    ds_read_b128 v[88:91], v3 offset:0
    ds_read_b128 v[92:95], v3 offset:1024
    ds_read_b128 v[96:99], v3 offset:2048
    ds_add_rtn_u32 v106, v109, v104 offset:4
    s_bitcmp1_b32 s52, 14
    s_cbranch_scc1 L_bo33
    s_waitcnt vmcnt(4)
L_bo33:
    s_waitcnt vmcnt(6)
    v_dot2_f32_bf16 v40, v128, v4, 0
    v_dot2_f32_bf16 v40, v129, v5, v40
    v_dot2_f32_bf16 v40, v130, v6, v40
    v_dot2_f32_bf16 v40, v131, v7, v40
    buffer_load_dwordx4 v[128:131], v1, s[40:43], s56 offen offset:0 nt
    ds_read_b128 v[100:103], v3 offset:3072
    s_waitcnt lgkmcnt(3)
    v_dot2_f32_bf16 v72, v88, v4, 0
    v_dot2_f32_bf16 v72, v89, v5, v72
    v_dot2_f32_bf16 v72, v90, v6, v72
    v_dot2_f32_bf16 v72, v91, v7, v72
    ds_read_b128 v[88:91], v3 offset:4096
    s_waitcnt lgkmcnt(3)
    v_dot2_f32_bf16 v73, v92, v4, 0
    v_dot2_f32_bf16 v73, v93, v5, v73
    v_dot2_f32_bf16 v73, v94, v6, v73
    v_dot2_f32_bf16 v73, v95, v7, v73
    ds_read_b32 v105, v109 offset:8
    s_bitcmp1_b32 s52, 15
    s_cbranch_scc1 L_bo34
    s_waitcnt vmcnt(4)
L_bo34:
    s_waitcnt vmcnt(6)
    v_dot2_f32_bf16 v41, v132, v4, 0
    v_dot2_f32_bf16 v41, v133, v5, v41
    v_dot2_f32_bf16 v41, v134, v6, v41
    v_dot2_f32_bf16 v41, v135, v7, v41
    buffer_load_dwordx4 v[132:135], v1, s[40:43], s56 offen offset:1024 nt
    ds_read_b128 v[92:95], v3 offset:5120
    s_waitcnt lgkmcnt(3)
    v_dot2_f32_bf16 v74, v96, v4, 0
    v_dot2_f32_bf16 v74, v97, v5, v74
    v_dot2_f32_bf16 v74, v98, v6, v74
    v_dot2_f32_bf16 v74, v99, v7, v74
    s_waitcnt lgkmcnt(0)
    v_readfirstlane_b32 s52, v105
    v_readfirstlane_b32 s60, v106
    s_add_u32 s52, s52, 1
    s_lshr_b32 s52, s52, 1
    s_sub_i32 s60, s60, s53
    s_add_u32 s53, s53, 16
    s_max_i32 s60, s60, 0
    s_mul_i32 s60, s60, 3
    s_add_u32 s52, s52, s60
    s_min_u32 s52, s52, 16
    s_bfm_b32 s52, s52, 0
    s_bitcmp1_b32 s52, 0
    s_cbranch_scc1 L_bo35
    s_waitcnt vmcnt(4)
L_bo35:
    s_waitcnt vmcnt(6)
    v_dot2_f32_bf16 v42, v136, v4, 0
    v_dot2_f32_bf16 v42, v137, v5, v42
    v_dot2_f32_bf16 v42, v138, v6, v42
    v_dot2_f32_bf16 v42, v139, v7, v42
    buffer_load_dwordx4 v[136:139], v1, s[40:43], s56 offen offset:2048 nt
    ds_read_b128 v[96:99], v3 offset:6144
    s_waitcnt lgkmcnt(3)
    v_dot2_f32_bf16 v75, v100, v4, 0
    v_dot2_f32_bf16 v75, v101, v5, v75
    v_dot2_f32_bf16 v75, v102, v6, v75
    v_dot2_f32_bf16 v75, v103, v7, v75
    s_bitcmp1_b32 s52, 1
    s_cbranch_scc1 L_bo36
    s_waitcnt vmcnt(4)
L_bo36:
    s_waitcnt vmcnt(6)
    v_dot2_f32_bf16 v43, v140, v4, 0
    v_dot2_f32_bf16 v43, v141, v5, v43
    v_dot2_f32_bf16 v43, v142, v6, v43
    v_dot2_f32_bf16 v43, v143, v7, v43
    buffer_load_dwordx4 v[140:143], v1, s[40:43], s56 offen offset:3072 nt
    s_add_u32 s56, s6, 65536
    ds_read_b128 v[100:103], v3 offset:7168
    s_waitcnt lgkmcnt(3)
    v_dot2_f32_bf16 v76, v88, v4, 0
    v_dot2_f32_bf16 v76, v89, v5, v76
    v_dot2_f32_bf16 v76, v90, v6, v76
    v_dot2_f32_bf16 v76, v91, v7, v76
    ds_read_b128 v[88:91], v3 offset:8192
    s_waitcnt lgkmcnt(3)
    v_dot2_f32_bf16 v77, v92, v4, 0
    v_dot2_f32_bf16 v77, v93, v5, v77
    v_dot2_f32_bf16 v77, v94, v6, v77
    v_dot2_f32_bf16 v77, v95, v7, v77
    ds_add_u32 v109, v104 offset:4
    s_bitcmp1_b32 s52, 2
    s_cbranch_scc1 L_bo37
    s_waitcnt vmcnt(4)
L_bo37:
    s_waitcnt vmcnt(6)
    v_dot2_f32_bf16 v44, v144, v4, 0
    v_dot2_f32_bf16 v44, v145, v5, v44
    v_dot2_f32_bf16 v44, v146, v6, v44
    v_dot2_f32_bf16 v44, v147, v7, v44
    buffer_load_dwordx4 v[144:147], v1, s[40:43], s56 offen offset:0 nt
    ds_read_b128 v[92:95], v3 offset:9216
    s_waitcnt lgkmcnt(3)
    v_dot2_f32_bf16 v78, v96, v4, 0
    v_dot2_f32_bf16 v78, v97, v5, v78
    v_dot2_f32_bf16 v78, v98, v6, v78
    v_dot2_f32_bf16 v78, v99, v7, v78
    s_bitcmp1_b32 s52, 3
    s_cbranch_scc1 L_bo38
    s_waitcnt vmcnt(4)
L_bo38:
    s_waitcnt vmcnt(6)
    v_dot2_f32_bf16 v45, v148, v4, 0
    v_dot2_f32_bf16 v45, v149, v5, v45
    v_dot2_f32_bf16 v45, v150, v6, v45
    v_dot2_f32_bf16 v45, v151, v7, v45
    buffer_load_dwordx4 v[148:151], v1, s[40:43], s56 offen offset:1024 nt
    ds_read_b128 v[96:99], v3 offset:10240
    s_waitcnt lgkmcnt(3)
    v_dot2_f32_bf16 v79, v100, v4, 0
    v_dot2_f32_bf16 v79, v101, v5, v79
    v_dot2_f32_bf16 v79, v102, v6, v79
    v_dot2_f32_bf16 v79, v103, v7, v79
    s_bitcmp1_b32 s52, 4
    s_cbranch_scc1 L_bo39
    s_waitcnt vmcnt(4)
L_bo39:
    s_waitcnt vmcnt(6)
    v_dot2_f32_bf16 v46, v152, v4, 0
    v_dot2_f32_bf16 v46, v153, v5, v46
    v_dot2_f32_bf16 v46, v154, v6, v46
    v_dot2_f32_bf16 v46, v155, v7, v46
    buffer_load_dwordx4 v[152:155], v1, s[40:43], s56 offen offset:2048 nt
    ds_read_b128 v[100:103], v3 offset:11264
    s_waitcnt lgkmcnt(3)
    v_dot2_f32_bf16 v80, v88, v4, 0
    v_dot2_f32_bf16 v80, v89, v5, v80
    v_dot2_f32_bf16 v80, v90, v6, v80
    v_dot2_f32_bf16 v80, v91, v7, v80
    ds_read_b128 v[88:91], v3 offset:12288
    s_waitcnt lgkmcnt(3)
    v_dot2_f32_bf16 v81, v92, v4, 0
    v_dot2_f32_bf16 v81, v93, v5, v81
    v_dot2_f32_bf16 v81, v94, v6, v81
    v_dot2_f32_bf16 v81, v95, v7, v81
    s_bitcmp1_b32 s52, 5
    s_cbranch_scc1 L_bo40
    s_waitcnt vmcnt(4)
L_bo40:
    s_waitcnt vmcnt(6)
    v_dot2_f32_bf16 v47, v156, v4, 0
    v_dot2_f32_bf16 v47, v157, v5, v47
    v_dot2_f32_bf16 v47, v158, v6, v47
    v_dot2_f32_bf16 v47, v159, v7, v47
    buffer_load_dwordx4 v[156:159], v1, s[40:43], s56 offen offset:3072 nt
    s_add_u32 s56, s6, 32768
    ds_read_b128 v[92:95], v3 offset:13312
    s_waitcnt lgkmcnt(3)
    v_dot2_f32_bf16 v82, v96, v4, 0
    v_dot2_f32_bf16 v82, v97, v5, v82
    v_dot2_f32_bf16 v82, v98, v6, v82
    v_dot2_f32_bf16 v82, v99, v7, v82
    ds_add_u32 v109, v104 offset:4
    s_bitcmp1_b32 s52, 6
    s_cbranch_scc1 L_bo41
    s_waitcnt vmcnt(4)
L_bo41:
    s_waitcnt vmcnt(6)
    v_dot2_f32_bf16 v48, v160, v4, 0
    v_dot2_f32_bf16 v48, v161, v5, v48
    v_dot2_f32_bf16 v48, v162, v6, v48
    v_dot2_f32_bf16 v48, v163, v7, v48
    buffer_load_dwordx4 v[160:163], v1, s[40:43], s56 offen offset:0 nt
    ds_read_b128 v[96:99], v3 offset:14336
    s_waitcnt lgkmcnt(3)
    v_dot2_f32_bf16 v83, v100, v4, 0
    v_dot2_f32_bf16 v83, v101, v5, v83
    v_dot2_f32_bf16 v83, v102, v6, v83
    v_dot2_f32_bf16 v83, v103, v7, v83
    s_bitcmp1_b32 s52, 7
    s_cbranch_scc1 L_bo42
    s_waitcnt vmcnt(4)
L_bo42:
    s_waitcnt vmcnt(6)
    v_dot2_f32_bf16 v49, v164, v4, 0
    v_dot2_f32_bf16 v49, v165, v5, v49
    v_dot2_f32_bf16 v49, v166, v6, v49
    v_dot2_f32_bf16 v49, v167, v7, v49
    buffer_load_dwordx4 v[164:167], v1, s[40:43], s56 offen offset:1024 nt
    ds_read_b128 v[100:103], v3 offset:15360
    s_waitcnt lgkmcnt(3)
    v_dot2_f32_bf16 v84, v88, v4, 0
    v_dot2_f32_bf16 v84, v89, v5, v84
    v_dot2_f32_bf16 v84, v90, v6, v84
    v_dot2_f32_bf16 v84, v91, v7, v84
    ds_read_b128 v[88:91], v3 offset:16384
    s_waitcnt lgkmcnt(3)
    v_dot2_f32_bf16 v85, v92, v4, 0
    v_dot2_f32_bf16 v85, v93, v5, v85
    v_dot2_f32_bf16 v85, v94, v6, v85
    v_dot2_f32_bf16 v85, v95, v7, v85
    s_bitcmp1_b32 s52, 8
    s_cbranch_scc1 L_bo43
    s_waitcnt vmcnt(4)
L_bo43:
    s_waitcnt vmcnt(6)
    v_dot2_f32_bf16 v50, v168, v4, 0
    v_dot2_f32_bf16 v50, v169, v5, v50
    v_dot2_f32_bf16 v50, v170, v6, v50
    v_dot2_f32_bf16 v50, v171, v7, v50
    buffer_load_dwordx4 v[168:171], v1, s[40:43], s56 offen offset:2048 nt
    ds_read_b128 v[92:95], v3 offset:17408
    s_waitcnt lgkmcnt(3)
    v_dot2_f32_bf16 v86, v96, v4, 0
    v_dot2_f32_bf16 v86, v97, v5, v86
    v_dot2_f32_bf16 v86, v98, v6, v86
    v_dot2_f32_bf16 v86, v99, v7, v86
    s_bitcmp1_b32 s52, 9
    s_cbranch_scc1 L_bo44
    s_waitcnt vmcnt(4)
L_bo44:
    s_waitcnt vmcnt(6)
    v_dot2_f32_bf16 v51, v172, v4, 0
    v_dot2_f32_bf16 v51, v173, v5, v51
    v_dot2_f32_bf16 v51, v174, v6, v51
    v_dot2_f32_bf16 v51, v175, v7, v51
    buffer_load_dwordx4 v[172:175], v1, s[40:43], s56 offen offset:3072 nt
    s_add_u32 s56, s6, 98304
    ds_read_b128 v[96:99], v3 offset:18432
    s_waitcnt lgkmcnt(3)
    v_dot2_f32_bf16 v87, v100, v4, 0
    v_dot2_f32_bf16 v87, v101, v5, v87
    v_dot2_f32_bf16 v87, v102, v6, v87
    v_dot2_f32_bf16 v87, v103, v7, v87
    v_add_f32_dpp v72, v72, v72 row_ror:8 row_mask:0xf bank_mask:0x3
    v_add_f32_dpp v72, v73, v73 row_ror:8 row_mask:0xf bank_mask:0xc
    v_add_f32_dpp v74, v74, v74 row_ror:8 row_mask:0xf bank_mask:0x3
    v_add_f32_dpp v74, v75, v75 row_ror:8 row_mask:0xf bank_mask:0xc
    v_add_f32_dpp v76, v76, v76 row_ror:8 row_mask:0xf bank_mask:0x3
    v_add_f32_dpp v76, v77, v77 row_ror:8 row_mask:0xf bank_mask:0xc
    v_add_f32_dpp v78, v78, v78 row_ror:8 row_mask:0xf bank_mask:0x3
    v_add_f32_dpp v78, v79, v79 row_ror:8 row_mask:0xf bank_mask:0xc
    v_add_f32_dpp v80, v80, v80 row_ror:8 row_mask:0xf bank_mask:0x3
    v_add_f32_dpp v80, v81, v81 row_ror:8 row_mask:0xf bank_mask:0xc
    v_add_f32_dpp v82, v82, v82 row_ror:8 row_mask:0xf bank_mask:0x3
    v_add_f32_dpp v82, v83, v83 row_ror:8 row_mask:0xf bank_mask:0xc
    v_add_f32_dpp v84, v84, v84 row_ror:8 row_mask:0xf bank_mask:0x3
    v_add_f32_dpp v84, v85, v85 row_ror:8 row_mask:0xf bank_mask:0xc
    v_add_f32_dpp v86, v86, v86 row_ror:8 row_mask:0xf bank_mask:0x3
    v_add_f32_dpp v86, v87, v87 row_ror:8 row_mask:0xf bank_mask:0xc
    v_add_f32_dpp v72, v72, v72 row_shl:4 row_mask:0xf bank_mask:0x5
    v_add_f32_dpp v72, v74, v74 row_shr:4 row_mask:0xf bank_mask:0xa
    v_add_f32_dpp v76, v76, v76 row_shl:4 row_mask:0xf bank_mask:0x5
    v_add_f32_dpp v76, v78, v78 row_shr:4 row_mask:0xf bank_mask:0xa
    v_add_f32_dpp v80, v80, v80 row_shl:4 row_mask:0xf bank_mask:0x5
    v_add_f32_dpp v80, v82, v82 row_shr:4 row_mask:0xf bank_mask:0xa
    v_add_f32_dpp v84, v84, v84 row_shl:4 row_mask:0xf bank_mask:0x5
    v_add_f32_dpp v84, v86, v86 row_shr:4 row_mask:0xf bank_mask:0xa
    v_add_f32_dpp v72, v72, v72 quad_perm:[1,0,3,2] row_mask:0xf bank_mask:0xf
    v_add_f32_dpp v76, v76, v76 quad_perm:[1,0,3,2] row_mask:0xf bank_mask:0xf
    v_add_f32_dpp v80, v80, v80 quad_perm:[1,0,3,2] row_mask:0xf bank_mask:0xf
    v_add_f32_dpp v84, v84, v84 quad_perm:[1,0,3,2] row_mask:0xf bank_mask:0xf
    v_cndmask_b32 v72, v72, v76, s[62:63]
    v_cndmask_b32 v80, v80, v84, s[62:63]
    s_nop 0
    v_add_f32_dpp v72, v72, v72 quad_perm:[2,3,0,1] row_mask:0xf bank_mask:0xf
    v_add_f32_dpp v80, v80, v80 quad_perm:[2,3,0,1] row_mask:0xf bank_mask:0xf
    v_cndmask_b32 v29, v72, v80, s[64:65]
    ds_add_u32 v109, v104 offset:4
    s_bitcmp1_b32 s52, 10
    s_cbranch_scc1 L_bo45
    s_waitcnt vmcnt(4)
L_bo45:
    s_waitcnt vmcnt(6)
    v_dot2_f32_bf16 v52, v176, v4, 0
    v_dot2_f32_bf16 v52, v177, v5, v52
    v_dot2_f32_bf16 v52, v178, v6, v52
    v_dot2_f32_bf16 v52, v179, v7, v52
    buffer_load_dwordx4 v[176:179], v1, s[40:43], s56 offen offset:0 nt
    ds_read_b128 v[100:103], v3 offset:19456
    s_waitcnt lgkmcnt(3)
    v_dot2_f32_bf16 v72, v88, v4, 0
    v_dot2_f32_bf16 v72, v89, v5, v72
    v_dot2_f32_bf16 v72, v90, v6, v72
    v_dot2_f32_bf16 v72, v91, v7, v72
    ds_read_b128 v[88:91], v3 offset:20480
    s_waitcnt lgkmcnt(3)
    v_dot2_f32_bf16 v73, v92, v4, 0
    v_dot2_f32_bf16 v73, v93, v5, v73
    v_dot2_f32_bf16 v73, v94, v6, v73
    v_dot2_f32_bf16 v73, v95, v7, v73
    s_bitcmp1_b32 s52, 11
    s_cbranch_scc1 L_bo46
    s_waitcnt vmcnt(4)
L_bo46:
    s_waitcnt vmcnt(6)
    v_dot2_f32_bf16 v53, v180, v4, 0
    v_dot2_f32_bf16 v53, v181, v5, v53
    v_dot2_f32_bf16 v53, v182, v6, v53
    v_dot2_f32_bf16 v53, v183, v7, v53
    buffer_load_dwordx4 v[180:183], v1, s[40:43], s56 offen offset:1024 nt
    ds_read_b128 v[92:95], v3 offset:21504
    s_waitcnt lgkmcnt(3)
    v_dot2_f32_bf16 v74, v96, v4, 0
    v_dot2_f32_bf16 v74, v97, v5, v74
    v_dot2_f32_bf16 v74, v98, v6, v74
    v_dot2_f32_bf16 v74, v99, v7, v74
    s_bitcmp1_b32 s52, 12
    s_cbranch_scc1 L_bo47
    s_waitcnt vmcnt(4)
L_bo47:
    s_waitcnt vmcnt(6)
    v_dot2_f32_bf16 v54, v184, v4, 0
    v_dot2_f32_bf16 v54, v185, v5, v54
    v_dot2_f32_bf16 v54, v186, v6, v54
    v_dot2_f32_bf16 v54, v187, v7, v54
    buffer_load_dwordx4 v[184:187], v1, s[40:43], s56 offen offset:2048 nt
    ds_read_b128 v[96:99], v3 offset:22528
    s_waitcnt lgkmcnt(3)
    v_dot2_f32_bf16 v75, v100, v4, 0
    v_dot2_f32_bf16 v75, v101, v5, v75
    v_dot2_f32_bf16 v75, v102, v6, v75
    v_dot2_f32_bf16 v75, v103, v7, v75
    s_bitcmp1_b32 s52, 13
    s_cbranch_scc1 L_bo48
    s_waitcnt vmcnt(5)
L_bo48:
    s_waitcnt vmcnt(7)
    v_dot2_f32_bf16 v55, v188, v4, 0
    v_dot2_f32_bf16 v55, v189, v5, v55
    v_dot2_f32_bf16 v55, v190, v6, v55
    v_dot2_f32_bf16 v55, v191, v7, v55
    buffer_load_dwordx4 v[188:191], v1, s[40:43], s56 offen offset:3072 nt
    s_add_u32 s56, s7, 0
    v_add_f32_dpp v40, v40, v40 row_ror:8 row_mask:0xf bank_mask:0x3
    v_add_f32_dpp v40, v41, v41 row_ror:8 row_mask:0xf bank_mask:0xc
    v_add_f32_dpp v42, v42, v42 row_ror:8 row_mask:0xf bank_mask:0x3
    v_add_f32_dpp v42, v43, v43 row_ror:8 row_mask:0xf bank_mask:0xc
    v_add_f32_dpp v44, v44, v44 row_ror:8 row_mask:0xf bank_mask:0x3
    v_add_f32_dpp v44, v45, v45 row_ror:8 row_mask:0xf bank_mask:0xc
    v_add_f32_dpp v46, v46, v46 row_ror:8 row_mask:0xf bank_mask:0x3
    v_add_f32_dpp v46, v47, v47 row_ror:8 row_mask:0xf bank_mask:0xc
    v_add_f32_dpp v48, v48, v48 row_ror:8 row_mask:0xf bank_mask:0x3
    v_add_f32_dpp v48, v49, v49 row_ror:8 row_mask:0xf bank_mask:0xc
    v_add_f32_dpp v50, v50, v50 row_ror:8 row_mask:0xf bank_mask:0x3
    v_add_f32_dpp v50, v51, v51 row_ror:8 row_mask:0xf bank_mask:0xc
    v_add_f32_dpp v52, v52, v52 row_ror:8 row_mask:0xf bank_mask:0x3
    v_add_f32_dpp v52, v53, v53 row_ror:8 row_mask:0xf bank_mask:0xc
    v_add_f32_dpp v54, v54, v54 row_ror:8 row_mask:0xf bank_mask:0x3
    v_add_f32_dpp v54, v55, v55 row_ror:8 row_mask:0xf bank_mask:0xc
    v_add_f32_dpp v40, v40, v40 row_shl:4 row_mask:0xf bank_mask:0x5
    v_add_f32_dpp v40, v42, v42 row_shr:4 row_mask:0xf bank_mask:0xa
    v_add_f32_dpp v44, v44, v44 row_shl:4 row_mask:0xf bank_mask:0x5
    v_add_f32_dpp v44, v46, v46 row_shr:4 row_mask:0xf bank_mask:0xa
    v_add_f32_dpp v48, v48, v48 row_shl:4 row_mask:0xf bank_mask:0x5
    v_add_f32_dpp v48, v50, v50 row_shr:4 row_mask:0xf bank_mask:0xa
    v_add_f32_dpp v52, v52, v52 row_shl:4 row_mask:0xf bank_mask:0x5
    v_add_f32_dpp v52, v54, v54 row_shr:4 row_mask:0xf bank_mask:0xa
    v_add_f32_dpp v40, v40, v40 quad_perm:[1,0,3,2] row_mask:0xf bank_mask:0xf
    v_add_f32_dpp v44, v44, v44 quad_perm:[1,0,3,2] row_mask:0xf bank_mask:0xf
    v_add_f32_dpp v48, v48, v48 quad_perm:[1,0,3,2] row_mask:0xf bank_mask:0xf
    v_add_f32_dpp v52, v52, v52 quad_perm:[1,0,3,2] row_mask:0xf bank_mask:0xf
    v_cndmask_b32 v40, v40, v44, s[62:63]
    v_cndmask_b32 v48, v48, v52, s[62:63]
    s_nop 0
    v_add_f32_dpp v40, v40, v40 quad_perm:[2,3,0,1] row_mask:0xf bank_mask:0xf
    v_add_f32_dpp v48, v48, v48 quad_perm:[2,3,0,1] row_mask:0xf bank_mask:0xf
    v_cndmask_b32 v27, v40, v48, s[64:65]
    ds_read_b128 v[100:103], v3 offset:23552
    s_waitcnt lgkmcnt(3)
    v_dot2_f32_bf16 v76, v88, v4, 0
    v_dot2_f32_bf16 v76, v89, v5, v76
    v_dot2_f32_bf16 v76, v90, v6, v76
    v_dot2_f32_bf16 v76, v91, v7, v76
    ds_read_b128 v[88:91], v3 offset:24576
    s_waitcnt lgkmcnt(3)
    v_dot2_f32_bf16 v77, v92, v4, 0
    v_dot2_f32_bf16 v77, v93, v5, v77
    v_dot2_f32_bf16 v77, v94, v6, v77
    v_dot2_f32_bf16 v77, v95, v7, v77
    ds_add_rtn_u32 v106, v109, v104 offset:4
    s_bitcmp1_b32 s52, 14
    s_cbranch_scc1 L_bo49
    s_waitcnt vmcnt(4)
L_bo49:
    s_waitcnt vmcnt(6)
    v_dot2_f32_bf16 v40, v192, v4, 0
    v_dot2_f32_bf16 v40, v193, v5, v40
    v_dot2_f32_bf16 v40, v194, v6, v40
    v_dot2_f32_bf16 v40, v195, v7, v40
    buffer_load_dwordx4 v[192:195], v1, s[40:43], s56 offen offset:0 nt
    ds_read_b128 v[92:95], v3 offset:25600
    s_waitcnt lgkmcnt(3)
    v_dot2_f32_bf16 v78, v96, v4, 0
    v_dot2_f32_bf16 v78, v97, v5, v78
    v_dot2_f32_bf16 v78, v98, v6, v78
    v_dot2_f32_bf16 v78, v99, v7, v78
    ds_read_b32 v105, v109 offset:8
    s_bitcmp1_b32 s52, 15
    s_cbranch_scc1 L_bo50
    s_waitcnt vmcnt(4)
L_bo50:
    s_waitcnt vmcnt(6)
    v_dot2_f32_bf16 v41, v196, v4, 0
    v_dot2_f32_bf16 v41, v197, v5, v41
    v_dot2_f32_bf16 v41, v198, v6, v41
    v_dot2_f32_bf16 v41, v199, v7, v41
    buffer_load_dwordx4 v[196:199], v1, s[40:43], s56 offen offset:1024 nt
    ds_read_b128 v[96:99], v3 offset:26624
    s_waitcnt lgkmcnt(3)
    v_dot2_f32_bf16 v79, v100, v4, 0
    v_dot2_f32_bf16 v79, v101, v5, v79
    v_dot2_f32_bf16 v79, v102, v6, v79
    v_dot2_f32_bf16 v79, v103, v7, v79
    s_waitcnt lgkmcnt(0)
    v_readfirstlane_b32 s52, v105
    v_readfirstlane_b32 s60, v106
    s_lshr_b32 s52, s52, 1
    s_sub_i32 s60, s60, s53
    s_add_u32 s53, s53, 16
    s_max_i32 s60, s60, 0
    s_mul_i32 s60, s60, 3
    s_add_u32 s52, s52, s60
    s_min_u32 s52, s52, 16
    s_bfm_b32 s52, s52, 0
    s_bitcmp1_b32 s52, 0
    s_cbranch_scc1 L_bo51
    s_waitcnt vmcnt(4)
L_bo51:
    s_waitcnt vmcnt(6)
    v_dot2_f32_bf16 v42, v200, v4, 0
    v_dot2_f32_bf16 v42, v201, v5, v42
    v_dot2_f32_bf16 v42, v202, v6, v42
    v_dot2_f32_bf16 v42, v203, v7, v42
    buffer_load_dwordx4 v[200:203], v1, s[40:43], s56 offen offset:2048 nt
    ds_read_b128 v[100:103], v3 offset:27648
    s_waitcnt lgkmcnt(3)
    v_dot2_f32_bf16 v80, v88, v4, 0
    v_dot2_f32_bf16 v80, v89, v5, v80
    v_dot2_f32_bf16 v80, v90, v6, v80
    v_dot2_f32_bf16 v80, v91, v7, v80
    ds_read_b128 v[88:91], v3 offset:28672
    s_waitcnt lgkmcnt(3)
    v_dot2_f32_bf16 v81, v92, v4, 0
    v_dot2_f32_bf16 v81, v93, v5, v81
    v_dot2_f32_bf16 v81, v94, v6, v81
    v_dot2_f32_bf16 v81, v95, v7, v81
    s_bitcmp1_b32 s52, 1
    s_cbranch_scc1 L_bo52
    s_waitcnt vmcnt(4)
L_bo52:
    s_waitcnt vmcnt(6)
    v_dot2_f32_bf16 v43, v204, v4, 0
    v_dot2_f32_bf16 v43, v205, v5, v43
    v_dot2_f32_bf16 v43, v206, v6, v43
    v_dot2_f32_bf16 v43, v207, v7, v43
    buffer_load_dwordx4 v[204:207], v1, s[40:43], s56 offen offset:3072 nt
    s_add_u32 s56, s7, 65536
    ds_read_b128 v[92:95], v3 offset:29696
    s_waitcnt lgkmcnt(3)
    v_dot2_f32_bf16 v82, v96, v4, 0
    v_dot2_f32_bf16 v82, v97, v5, v82
    v_dot2_f32_bf16 v82, v98, v6, v82
    v_dot2_f32_bf16 v82, v99, v7, v82
    ds_add_u32 v109, v104 offset:4
    s_bitcmp1_b32 s52, 2
    s_cbranch_scc1 L_bo53
    s_waitcnt vmcnt(4)
L_bo53:
    s_waitcnt vmcnt(6)
    v_dot2_f32_bf16 v44, v208, v4, 0
    v_dot2_f32_bf16 v44, v209, v5, v44
    v_dot2_f32_bf16 v44, v210, v6, v44
    v_dot2_f32_bf16 v44, v211, v7, v44
    buffer_load_dwordx4 v[208:211], v1, s[40:43], s56 offen offset:0 nt
    ds_read_b128 v[96:99], v3 offset:30720
    s_waitcnt lgkmcnt(3)
    v_dot2_f32_bf16 v83, v100, v4, 0
    v_dot2_f32_bf16 v83, v101, v5, v83
    v_dot2_f32_bf16 v83, v102, v6, v83
    v_dot2_f32_bf16 v83, v103, v7, v83
    s_bitcmp1_b32 s52, 3
    s_cbranch_scc1 L_bo54
    s_waitcnt vmcnt(4)
L_bo54:
    s_waitcnt vmcnt(6)
    v_dot2_f32_bf16 v45, v212, v4, 0
    v_dot2_f32_bf16 v45, v213, v5, v45
    v_dot2_f32_bf16 v45, v214, v6, v45
    v_dot2_f32_bf16 v45, v215, v7, v45
    buffer_load_dwordx4 v[212:215], v1, s[40:43], s56 offen offset:1024 nt
    ds_read_b128 v[100:103], v3 offset:31744
    s_waitcnt lgkmcnt(3)
    v_dot2_f32_bf16 v84, v88, v4, 0
    v_dot2_f32_bf16 v84, v89, v5, v84
    v_dot2_f32_bf16 v84, v90, v6, v84
    v_dot2_f32_bf16 v84, v91, v7, v84
    s_waitcnt lgkmcnt(2)
    v_dot2_f32_bf16 v85, v92, v4, 0
    v_dot2_f32_bf16 v85, v93, v5, v85
    v_dot2_f32_bf16 v85, v94, v6, v85
    v_dot2_f32_bf16 v85, v95, v7, v85
    s_bitcmp1_b32 s52, 4
    s_cbranch_scc1 L_bo55
    s_waitcnt vmcnt(4)
L_bo55:
    s_waitcnt vmcnt(6)
    v_dot2_f32_bf16 v46, v216, v4, 0
    v_dot2_f32_bf16 v46, v217, v5, v46
    v_dot2_f32_bf16 v46, v218, v6, v46
    v_dot2_f32_bf16 v46, v219, v7, v46
    buffer_load_dwordx4 v[216:219], v1, s[40:43], s56 offen offset:2048 nt
    s_waitcnt lgkmcnt(1)
    v_dot2_f32_bf16 v86, v96, v4, 0
    v_dot2_f32_bf16 v86, v97, v5, v86
    v_dot2_f32_bf16 v86, v98, v6, v86
    v_dot2_f32_bf16 v86, v99, v7, v86
    s_bitcmp1_b32 s52, 5
    s_cbranch_scc1 L_bo56
    s_waitcnt vmcnt(4)
L_bo56:
    s_waitcnt vmcnt(6)
    v_dot2_f32_bf16 v47, v220, v4, 0
    v_dot2_f32_bf16 v47, v221, v5, v47
    v_dot2_f32_bf16 v47, v222, v6, v47
    v_dot2_f32_bf16 v47, v223, v7, v47
    buffer_load_dwordx4 v[220:223], v1, s[40:43], s56 offen offset:3072 nt
    s_add_u32 s56, s7, 32768
    s_waitcnt lgkmcnt(0)
    v_dot2_f32_bf16 v87, v100, v4, 0
    v_dot2_f32_bf16 v87, v101, v5, v87
    v_dot2_f32_bf16 v87, v102, v6, v87
    v_dot2_f32_bf16 v87, v103, v7, v87
    v_add_f32_dpp v72, v72, v72 row_ror:8 row_mask:0xf bank_mask:0x3
    v_add_f32_dpp v72, v73, v73 row_ror:8 row_mask:0xf bank_mask:0xc
    v_add_f32_dpp v74, v74, v74 row_ror:8 row_mask:0xf bank_mask:0x3
    v_add_f32_dpp v74, v75, v75 row_ror:8 row_mask:0xf bank_mask:0xc
    v_add_f32_dpp v76, v76, v76 row_ror:8 row_mask:0xf bank_mask:0x3
    v_add_f32_dpp v76, v77, v77 row_ror:8 row_mask:0xf bank_mask:0xc
    v_add_f32_dpp v78, v78, v78 row_ror:8 row_mask:0xf bank_mask:0x3
    v_add_f32_dpp v78, v79, v79 row_ror:8 row_mask:0xf bank_mask:0xc
    v_add_f32_dpp v80, v80, v80 row_ror:8 row_mask:0xf bank_mask:0x3
    v_add_f32_dpp v80, v81, v81 row_ror:8 row_mask:0xf bank_mask:0xc
    v_add_f32_dpp v82, v82, v82 row_ror:8 row_mask:0xf bank_mask:0x3
    v_add_f32_dpp v82, v83, v83 row_ror:8 row_mask:0xf bank_mask:0xc
    v_add_f32_dpp v84, v84, v84 row_ror:8 row_mask:0xf bank_mask:0x3
    v_add_f32_dpp v84, v85, v85 row_ror:8 row_mask:0xf bank_mask:0xc
    v_add_f32_dpp v86, v86, v86 row_ror:8 row_mask:0xf bank_mask:0x3
    v_add_f32_dpp v86, v87, v87 row_ror:8 row_mask:0xf bank_mask:0xc
    v_add_f32_dpp v72, v72, v72 row_shl:4 row_mask:0xf bank_mask:0x5
    v_add_f32_dpp v72, v74, v74 row_shr:4 row_mask:0xf bank_mask:0xa
    v_add_f32_dpp v76, v76, v76 row_shl:4 row_mask:0xf bank_mask:0x5
    v_add_f32_dpp v76, v78, v78 row_shr:4 row_mask:0xf bank_mask:0xa
    v_add_f32_dpp v80, v80, v80 row_shl:4 row_mask:0xf bank_mask:0x5
    v_add_f32_dpp v80, v82, v82 row_shr:4 row_mask:0xf bank_mask:0xa
    v_add_f32_dpp v84, v84, v84 row_shl:4 row_mask:0xf bank_mask:0x5
    v_add_f32_dpp v84, v86, v86 row_shr:4 row_mask:0xf bank_mask:0xa
    v_add_f32_dpp v72, v72, v72 quad_perm:[1,0,3,2] row_mask:0xf bank_mask:0xf
    v_add_f32_dpp v76, v76, v76 quad_perm:[1,0,3,2] row_mask:0xf bank_mask:0xf
    v_add_f32_dpp v80, v80, v80 quad_perm:[1,0,3,2] row_mask:0xf bank_mask:0xf
    v_add_f32_dpp v84, v84, v84 quad_perm:[1,0,3,2] row_mask:0xf bank_mask:0xf
    v_cndmask_b32 v72, v72, v76, s[62:63]
    v_cndmask_b32 v80, v80, v84, s[62:63]
    s_nop 0
    v_add_f32_dpp v72, v72, v72 quad_perm:[2,3,0,1] row_mask:0xf bank_mask:0xf
    v_add_f32_dpp v80, v80, v80 quad_perm:[2,3,0,1] row_mask:0xf bank_mask:0xf
    v_cndmask_b32 v72, v72, v80, s[64:65]
    ds_add_u32 v109, v104 offset:4
    s_bitcmp1_b32 s52, 6
    s_cbranch_scc1 L_bo57
    s_waitcnt vmcnt(4)
L_bo57:
    s_waitcnt vmcnt(6)
    v_dot2_f32_bf16 v48, v224, v4, 0
    v_dot2_f32_bf16 v48, v225, v5, v48
    v_dot2_f32_bf16 v48, v226, v6, v48
    v_dot2_f32_bf16 v48, v227, v7, v48
    buffer_load_dwordx4 v[224:227], v1, s[40:43], s56 offen offset:0 nt
    v_mov_b32 v32, v34
    v_mov_b32 v33, v35
    v_mov_b32 v34, v36
    v_mov_b32 v35, v37
    v_mov_b32 v36, v38
    v_mov_b32 v37, v39
    v_cvt_pk_bf16_f32 v26, v29, v72
    v_lshlrev_b32 v29, 16, v26
    v_and_b32 v26, 0xffff0000, v26
    v_mul_f32 v29, 0x3db504f3, v29
    v_mul_f32 v26, 0x3db504f3, v26
    v_cvt_pk_bf16_f32 v39, v29, v26
    s_bitcmp1_b32 s52, 7
    s_cbranch_scc1 L_bo58
    s_waitcnt vmcnt(4)
L_bo58:
    s_waitcnt vmcnt(6)
    v_dot2_f32_bf16 v49, v228, v4, 0
    v_dot2_f32_bf16 v49, v229, v5, v49
    v_dot2_f32_bf16 v49, v230, v6, v49
    v_dot2_f32_bf16 v49, v231, v7, v49
    buffer_load_dwordx4 v[228:231], v1, s[40:43], s56 offen offset:1024 nt
    v_lshlrev_b32 v24, 16, v32
    v_and_b32 v25, 0xffff0000, v32
    v_max_f32 v28, v24, v25
    v_lshlrev_b32 v24, 16, v33
    v_and_b32 v25, 0xffff0000, v33
    v_max3_f32 v28, v28, v24, v25
    v_lshlrev_b32 v24, 16, v34
    v_and_b32 v25, 0xffff0000, v34
    v_max3_f32 v28, v28, v24, v25
    v_lshlrev_b32 v24, 16, v35
    v_and_b32 v25, 0xffff0000, v35
    v_max3_f32 v28, v28, v24, v25
    v_lshlrev_b32 v24, 16, v36
    v_and_b32 v25, 0xffff0000, v36
    v_max3_f32 v28, v28, v24, v25
    v_lshlrev_b32 v24, 16, v37
    v_and_b32 v25, 0xffff0000, v37
    v_max3_f32 v28, v28, v24, v25
    v_lshlrev_b32 v24, 16, v39
    v_and_b32 v25, 0xffff0000, v39
    v_max3_f32 v28, v28, v24, v25
    s_bitcmp1_b32 s52, 8
    s_cbranch_scc1 L_bo59
    s_waitcnt vmcnt(4)
L_bo59:
    s_waitcnt vmcnt(6)
    v_dot2_f32_bf16 v50, v232, v4, 0
    v_dot2_f32_bf16 v50, v233, v5, v50
    v_dot2_f32_bf16 v50, v234, v6, v50
    v_dot2_f32_bf16 v50, v235, v7, v50
    buffer_load_dwordx4 v[232:235], v1, s[40:43], s56 offen offset:2048 nt
    v_mov_b32 v20, 0
    v_mov_b32 v21, 0
    v_mov_b32 v22, 0
    v_mov_b32 v23, 0
    s_lshr_b32 s59, s34, 1
    s_lshl_b32 s59, s59, 2
    v_subrev_u32 v2, s59, v0
    v_and_b32 v2, 15, v2
    v_lshrrev_b32 v26, 4, v0
    v_xor_b32 v26, s34, v26
    v_and_b32 v26, 1, v26
    v_lshlrev_b32 v2, 3, v2
    v_lshl_add_u32 v2, v26, 2, v2
    s_mul_i32 s59, s4, 160
    s_add_u32 s59, s59, 2048
    v_add_u32 v2, s59, v2
    s_lshl_b32 s59, s4, 2
    v_mov_b32 v108, s59
    s_bitcmp1_b32 s52, 9
    s_cbranch_scc1 L_bo60
    s_waitcnt vmcnt(4)
L_bo60:
    s_waitcnt vmcnt(6)
    v_dot2_f32_bf16 v51, v236, v4, 0
    v_dot2_f32_bf16 v51, v237, v5, v51
    v_dot2_f32_bf16 v51, v238, v6, v51
    v_dot2_f32_bf16 v51, v239, v7, v51
    buffer_load_dwordx4 v[236:239], v1, s[40:43], s56 offen offset:3072 nt
    s_add_u32 s56, s7, 98304
    ds_add_u32 v109, v104 offset:4
    s_bitcmp1_b32 s52, 10
    s_cbranch_scc1 L_bo61
    s_waitcnt vmcnt(4)
L_bo61:
    s_waitcnt vmcnt(6)
    v_dot2_f32_bf16 v52, v240, v4, 0
    v_dot2_f32_bf16 v52, v241, v5, v52
    v_dot2_f32_bf16 v52, v242, v6, v52
    v_dot2_f32_bf16 v52, v243, v7, v52
    buffer_load_dwordx4 v[240:243], v1, s[40:43], s56 offen offset:0 nt
    s_bitcmp1_b32 s52, 11
    s_cbranch_scc1 L_bo62
    s_waitcnt vmcnt(5)
L_bo62:
    s_waitcnt vmcnt(7)
    v_dot2_f32_bf16 v53, v244, v4, 0
    v_dot2_f32_bf16 v53, v245, v5, v53
    v_dot2_f32_bf16 v53, v246, v6, v53
    v_dot2_f32_bf16 v53, v247, v7, v53
    buffer_load_dwordx4 v[244:247], v1, s[40:43], s56 offen offset:1024 nt
    s_bitcmp1_b32 s52, 12
    s_cbranch_scc1 L_bo63
    s_waitcnt vmcnt(6)
L_bo63:
    s_waitcnt vmcnt(8)
    v_dot2_f32_bf16 v54, v248, v4, 0
    v_dot2_f32_bf16 v54, v249, v5, v54
    v_dot2_f32_bf16 v54, v250, v6, v54
    v_dot2_f32_bf16 v54, v251, v7, v54
    buffer_load_dwordx4 v[248:251], v1, s[40:43], s56 offen offset:2048 nt
    s_bitcmp1_b32 s52, 13
    s_cbranch_scc1 L_bo64
    s_waitcnt vmcnt(6)
L_bo64:
    s_waitcnt vmcnt(8)
    v_dot2_f32_bf16 v55, v252, v4, 0
    v_dot2_f32_bf16 v55, v253, v5, v55
    v_dot2_f32_bf16 v55, v254, v6, v55
    v_dot2_f32_bf16 v55, v255, v7, v55
    buffer_load_dwordx4 v[252:255], v1, s[40:43], s56 offen offset:3072 nt
    s_add_u32 s70, s70, 131072
    s_xor_b32 s6, s70, s71
    s_xor_b32 s7, s6, 16384
    s_add_u32 s56, s6, 0
    v_add_f32_dpp v40, v40, v40 row_ror:8 row_mask:0xf bank_mask:0x3
    v_add_f32_dpp v40, v41, v41 row_ror:8 row_mask:0xf bank_mask:0xc
    v_add_f32_dpp v42, v42, v42 row_ror:8 row_mask:0xf bank_mask:0x3
    v_add_f32_dpp v42, v43, v43 row_ror:8 row_mask:0xf bank_mask:0xc
    v_add_f32_dpp v44, v44, v44 row_ror:8 row_mask:0xf bank_mask:0x3
    v_add_f32_dpp v44, v45, v45 row_ror:8 row_mask:0xf bank_mask:0xc
    v_add_f32_dpp v46, v46, v46 row_ror:8 row_mask:0xf bank_mask:0x3
    v_add_f32_dpp v46, v47, v47 row_ror:8 row_mask:0xf bank_mask:0xc
    v_add_f32_dpp v48, v48, v48 row_ror:8 row_mask:0xf bank_mask:0x3
    v_add_f32_dpp v48, v49, v49 row_ror:8 row_mask:0xf bank_mask:0xc
    v_add_f32_dpp v50, v50, v50 row_ror:8 row_mask:0xf bank_mask:0x3
    v_add_f32_dpp v50, v51, v51 row_ror:8 row_mask:0xf bank_mask:0xc
    v_add_f32_dpp v52, v52, v52 row_ror:8 row_mask:0xf bank_mask:0x3
    v_add_f32_dpp v52, v53, v53 row_ror:8 row_mask:0xf bank_mask:0xc
    v_add_f32_dpp v54, v54, v54 row_ror:8 row_mask:0xf bank_mask:0x3
    v_add_f32_dpp v54, v55, v55 row_ror:8 row_mask:0xf bank_mask:0xc
    v_add_f32_dpp v40, v40, v40 row_shl:4 row_mask:0xf bank_mask:0x5
    v_add_f32_dpp v40, v42, v42 row_shr:4 row_mask:0xf bank_mask:0xa
    v_add_f32_dpp v44, v44, v44 row_shl:4 row_mask:0xf bank_mask:0x5
    v_add_f32_dpp v44, v46, v46 row_shr:4 row_mask:0xf bank_mask:0xa
    v_add_f32_dpp v48, v48, v48 row_shl:4 row_mask:0xf bank_mask:0x5
    v_add_f32_dpp v48, v50, v50 row_shr:4 row_mask:0xf bank_mask:0xa
    v_add_f32_dpp v52, v52, v52 row_shl:4 row_mask:0xf bank_mask:0x5
    v_add_f32_dpp v52, v54, v54 row_shr:4 row_mask:0xf bank_mask:0xa
    v_add_f32_dpp v40, v40, v40 quad_perm:[1,0,3,2] row_mask:0xf bank_mask:0xf
    v_add_f32_dpp v44, v44, v44 quad_perm:[1,0,3,2] row_mask:0xf bank_mask:0xf
    v_add_f32_dpp v48, v48, v48 quad_perm:[1,0,3,2] row_mask:0xf bank_mask:0xf
    v_add_f32_dpp v52, v52, v52 quad_perm:[1,0,3,2] row_mask:0xf bank_mask:0xf
    v_cndmask_b32 v40, v40, v44, s[62:63]
    v_cndmask_b32 v48, v48, v52, s[62:63]
    s_nop 0
    v_add_f32_dpp v40, v40, v40 quad_perm:[2,3,0,1] row_mask:0xf bank_mask:0xf
    v_add_f32_dpp v48, v48, v48 quad_perm:[2,3,0,1] row_mask:0xf bank_mask:0xf
    v_cndmask_b32 v40, v40, v48, s[64:65]
    v_cvt_pk_bf16_f32 v26, v27, v40
    v_lshlrev_b32 v27, 16, v26
    v_and_b32 v26, 0xffff0000, v26
    v_mul_f32 v27, 0x3db504f3, v27
    v_mul_f32 v26, 0x3db504f3, v26
    v_cvt_pk_bf16_f32 v38, v27, v26
    v_lshlrev_b32 v24, 16, v38
    v_and_b32 v25, 0xffff0000, v38
    v_max3_f32 v28, v28, v24, v25
    ds_write_b128 v3, v[32:35]
    ds_write_b128 v3, v[36:39] offset:1024
    s_nop 1
    v_max_f32_dpp v28, v28, v28 quad_perm:[1,0,3,2] row_mask:0xf bank_mask:0xf
    s_nop 1
    v_max_f32_dpp v28, v28, v28 quad_perm:[2,3,0,1] row_mask:0xf bank_mask:0xf
    s_nop 1
    v_max_f32_dpp v28, v28, v28 row_half_mirror row_mask:0xf bank_mask:0xf
    s_nop 1
    v_max_f32_dpp v28, v28, v28 row_mirror row_mask:0xf bank_mask:0xf
    v_mov_b32 v26, v28
    s_nop 1
    v_permlane16_swap_b32 v26, v28
    s_nop 1
    v_max_f32 v28, v28, v26
    v_mov_b32 v26, v28
    s_nop 1
    v_permlane32_swap_b32 v26, v28
    s_nop 1
    v_max_f32 v28, v28, v26
    ds_write_b32 v108, v28 offset:3328
    s_mov_b32 s57, 7
L_v:
    v_lshlrev_b32 v24, 16, v32
    v_and_b32 v25, 0xffff0000, v32
    v_sub_f32 v24, v24, v28
    v_sub_f32 v25, v25, v28
    v_mul_f32 v24, 0x3fb8aa3b, v24
    v_mul_f32 v25, 0x3fb8aa3b, v25
    v_exp_f32 v24, v24
    v_exp_f32 v25, v25
    s_nop 0
    v_cvt_pk_bf16_f32 v24, v24, v24
    v_cvt_pk_bf16_f32 v25, v25, v25
    v_mov_b32 v32, v33
    v_mov_b32 v33, v34
    v_mov_b32 v34, v35
    v_mov_b32 v35, v36
    v_mov_b32 v36, v37
    v_mov_b32 v37, v38
    v_mov_b32 v38, v39
    v_and_b32_dpp v12, v24, v8 row_newbcast:0 row_mask:0xf bank_mask:0xf
    v_and_b32_dpp v13, v24, v9 row_newbcast:0 row_mask:0xf bank_mask:0xf
    v_and_b32_dpp v14, v24, v10 row_newbcast:0 row_mask:0xf bank_mask:0xf
    v_and_b32_dpp v15, v24, v11 row_newbcast:0 row_mask:0xf bank_mask:0xf
    s_nop 0
    ds_add_rtn_u32 v106, v109, v104 offset:4
    s_bitcmp1_b32 s52, 14
    s_cbranch_scc1 L_bo65
    s_waitcnt vmcnt(4)
L_bo65:
    s_waitcnt vmcnt(6)
    v_mfma_f32_16x16x32_bf16 v[20:23], v[12:15], v[128:131], v[20:23]
    v_and_b32_dpp v16, v24, v8 row_newbcast:8 row_mask:0xf bank_mask:0xf
    v_and_b32_dpp v17, v24, v9 row_newbcast:8 row_mask:0xf bank_mask:0xf
    v_and_b32_dpp v18, v24, v10 row_newbcast:8 row_mask:0xf bank_mask:0xf
    v_and_b32_dpp v19, v24, v11 row_newbcast:8 row_mask:0xf bank_mask:0xf
    buffer_load_dwordx4 v[128:131], v1, s[40:43], s56 offen offset:0 nt
    ds_read_b32 v105, v109 offset:8
    s_bitcmp1_b32 s52, 15
    s_cbranch_scc1 L_bo66
    s_waitcnt vmcnt(4)
L_bo66:
    s_waitcnt vmcnt(6)
    v_mfma_f32_16x16x32_bf16 v[20:23], v[16:19], v[132:135], v[20:23]
    v_and_b32_dpp v12, v24, v8 row_newbcast:4 row_mask:0xf bank_mask:0xf
    v_and_b32_dpp v13, v24, v9 row_newbcast:4 row_mask:0xf bank_mask:0xf
    v_and_b32_dpp v14, v24, v10 row_newbcast:4 row_mask:0xf bank_mask:0xf
    v_and_b32_dpp v15, v24, v11 row_newbcast:4 row_mask:0xf bank_mask:0xf
    buffer_load_dwordx4 v[132:135], v1, s[40:43], s56 offen offset:1024 nt
    s_waitcnt lgkmcnt(0)
    v_readfirstlane_b32 s52, v105
    v_readfirstlane_b32 s60, v106
    s_add_u32 s52, s52, 1
    s_lshr_b32 s52, s52, 1
    s_sub_i32 s60, s60, s53
    s_add_u32 s53, s53, 16
    s_max_i32 s60, s60, 0
    s_mul_i32 s60, s60, 3
    s_add_u32 s52, s52, s60
    s_min_u32 s52, s52, 16
    s_bfm_b32 s52, s52, 0
    s_bitcmp1_b32 s52, 0
    s_cbranch_scc1 L_bo67
    s_waitcnt vmcnt(4)
L_bo67:
    s_waitcnt vmcnt(6)
    v_mfma_f32_16x16x32_bf16 v[20:23], v[12:15], v[136:139], v[20:23]
    v_and_b32_dpp v16, v24, v8 row_newbcast:12 row_mask:0xf bank_mask:0xf
    v_and_b32_dpp v17, v24, v9 row_newbcast:12 row_mask:0xf bank_mask:0xf
    v_and_b32_dpp v18, v24, v10 row_newbcast:12 row_mask:0xf bank_mask:0xf
    v_and_b32_dpp v19, v24, v11 row_newbcast:12 row_mask:0xf bank_mask:0xf
    buffer_load_dwordx4 v[136:139], v1, s[40:43], s56 offen offset:2048 nt
    s_bitcmp1_b32 s52, 1
    s_cbranch_scc1 L_bo68
    s_waitcnt vmcnt(4)
L_bo68:
    s_waitcnt vmcnt(6)
    v_mfma_f32_16x16x32_bf16 v[20:23], v[16:19], v[140:143], v[20:23]
    v_and_b32_dpp v12, v24, v8 row_newbcast:1 row_mask:0xf bank_mask:0xf
    v_and_b32_dpp v13, v24, v9 row_newbcast:1 row_mask:0xf bank_mask:0xf
    v_and_b32_dpp v14, v24, v10 row_newbcast:1 row_mask:0xf bank_mask:0xf
    v_and_b32_dpp v15, v24, v11 row_newbcast:1 row_mask:0xf bank_mask:0xf
    buffer_load_dwordx4 v[140:143], v1, s[40:43], s56 offen offset:3072 nt
    s_add_u32 s56, s6, 65536
    ds_add_u32 v109, v104 offset:4
    s_bitcmp1_b32 s52, 2
    s_cbranch_scc1 L_bo69
    s_waitcnt vmcnt(4)
L_bo69:
    s_waitcnt vmcnt(6)
    v_mfma_f32_16x16x32_bf16 v[20:23], v[12:15], v[144:147], v[20:23]
    v_and_b32_dpp v16, v24, v8 row_newbcast:9 row_mask:0xf bank_mask:0xf
    v_and_b32_dpp v17, v24, v9 row_newbcast:9 row_mask:0xf bank_mask:0xf
    v_and_b32_dpp v18, v24, v10 row_newbcast:9 row_mask:0xf bank_mask:0xf
    v_and_b32_dpp v19, v24, v11 row_newbcast:9 row_mask:0xf bank_mask:0xf
    buffer_load_dwordx4 v[144:147], v1, s[40:43], s56 offen offset:0 nt
    s_bitcmp1_b32 s52, 3
    s_cbranch_scc1 L_bo70
    s_waitcnt vmcnt(4)
L_bo70:
    s_waitcnt vmcnt(6)
    v_mfma_f32_16x16x32_bf16 v[20:23], v[16:19], v[148:151], v[20:23]
    v_and_b32_dpp v12, v24, v8 row_newbcast:5 row_mask:0xf bank_mask:0xf
    v_and_b32_dpp v13, v24, v9 row_newbcast:5 row_mask:0xf bank_mask:0xf
    v_and_b32_dpp v14, v24, v10 row_newbcast:5 row_mask:0xf bank_mask:0xf
    v_and_b32_dpp v15, v24, v11 row_newbcast:5 row_mask:0xf bank_mask:0xf
    buffer_load_dwordx4 v[148:151], v1, s[40:43], s56 offen offset:1024 nt
    s_bitcmp1_b32 s52, 4
    s_cbranch_scc1 L_bo71
    s_waitcnt vmcnt(4)
L_bo71:
    s_waitcnt vmcnt(6)
    v_mfma_f32_16x16x32_bf16 v[20:23], v[12:15], v[152:155], v[20:23]
    v_and_b32_dpp v16, v24, v8 row_newbcast:13 row_mask:0xf bank_mask:0xf
    v_and_b32_dpp v17, v24, v9 row_newbcast:13 row_mask:0xf bank_mask:0xf
    v_and_b32_dpp v18, v24, v10 row_newbcast:13 row_mask:0xf bank_mask:0xf
    v_and_b32_dpp v19, v24, v11 row_newbcast:13 row_mask:0xf bank_mask:0xf
    buffer_load_dwordx4 v[152:155], v1, s[40:43], s56 offen offset:2048 nt
    s_bitcmp1_b32 s52, 5
    s_cbranch_scc1 L_bo72
    s_waitcnt vmcnt(4)
L_bo72:
    s_waitcnt vmcnt(6)
    v_mfma_f32_16x16x32_bf16 v[20:23], v[16:19], v[156:159], v[20:23]
    v_and_b32_dpp v12, v24, v8 row_newbcast:2 row_mask:0xf bank_mask:0xf
    v_and_b32_dpp v13, v24, v9 row_newbcast:2 row_mask:0xf bank_mask:0xf
    v_and_b32_dpp v14, v24, v10 row_newbcast:2 row_mask:0xf bank_mask:0xf
    v_and_b32_dpp v15, v24, v11 row_newbcast:2 row_mask:0xf bank_mask:0xf
    buffer_load_dwordx4 v[156:159], v1, s[40:43], s56 offen offset:3072 nt
    s_add_u32 s56, s6, 32768
    ds_add_u32 v109, v104 offset:4
    s_bitcmp1_b32 s52, 6
    s_cbranch_scc1 L_bo73
    s_waitcnt vmcnt(4)
L_bo73:
    s_waitcnt vmcnt(6)
    v_mfma_f32_16x16x32_bf16 v[20:23], v[12:15], v[160:163], v[20:23]
    v_and_b32_dpp v16, v24, v8 row_newbcast:10 row_mask:0xf bank_mask:0xf
    v_and_b32_dpp v17, v24, v9 row_newbcast:10 row_mask:0xf bank_mask:0xf
    v_and_b32_dpp v18, v24, v10 row_newbcast:10 row_mask:0xf bank_mask:0xf
    v_and_b32_dpp v19, v24, v11 row_newbcast:10 row_mask:0xf bank_mask:0xf
    buffer_load_dwordx4 v[160:163], v1, s[40:43], s56 offen offset:0 nt
    s_bitcmp1_b32 s52, 7
    s_cbranch_scc1 L_bo74
    s_waitcnt vmcnt(4)
L_bo74:
    s_waitcnt vmcnt(6)
    v_mfma_f32_16x16x32_bf16 v[20:23], v[16:19], v[164:167], v[20:23]
    v_and_b32_dpp v12, v24, v8 row_newbcast:6 row_mask:0xf bank_mask:0xf
    v_and_b32_dpp v13, v24, v9 row_newbcast:6 row_mask:0xf bank_mask:0xf
    v_and_b32_dpp v14, v24, v10 row_newbcast:6 row_mask:0xf bank_mask:0xf
    v_and_b32_dpp v15, v24, v11 row_newbcast:6 row_mask:0xf bank_mask:0xf
    buffer_load_dwordx4 v[164:167], v1, s[40:43], s56 offen offset:1024 nt
    s_bitcmp1_b32 s52, 8
    s_cbranch_scc1 L_bo75
    s_waitcnt vmcnt(4)
L_bo75:
    s_waitcnt vmcnt(6)
    v_mfma_f32_16x16x32_bf16 v[20:23], v[12:15], v[168:171], v[20:23]
    v_and_b32_dpp v16, v24, v8 row_newbcast:14 row_mask:0xf bank_mask:0xf
    v_and_b32_dpp v17, v24, v9 row_newbcast:14 row_mask:0xf bank_mask:0xf
    v_and_b32_dpp v18, v24, v10 row_newbcast:14 row_mask:0xf bank_mask:0xf
    v_and_b32_dpp v19, v24, v11 row_newbcast:14 row_mask:0xf bank_mask:0xf
    buffer_load_dwordx4 v[168:171], v1, s[40:43], s56 offen offset:2048 nt
    s_bitcmp1_b32 s52, 9
    s_cbranch_scc1 L_bo76
    s_waitcnt vmcnt(4)
L_bo76:
    s_waitcnt vmcnt(6)
    v_mfma_f32_16x16x32_bf16 v[20:23], v[16:19], v[172:175], v[20:23]
    v_and_b32_dpp v12, v24, v8 row_newbcast:3 row_mask:0xf bank_mask:0xf
    v_and_b32_dpp v13, v24, v9 row_newbcast:3 row_mask:0xf bank_mask:0xf
    v_and_b32_dpp v14, v24, v10 row_newbcast:3 row_mask:0xf bank_mask:0xf
    v_and_b32_dpp v15, v24, v11 row_newbcast:3 row_mask:0xf bank_mask:0xf
    buffer_load_dwordx4 v[172:175], v1, s[40:43], s56 offen offset:3072 nt
    s_add_u32 s56, s6, 98304
    ds_add_u32 v109, v104 offset:4
    s_bitcmp1_b32 s52, 10
    s_cbranch_scc1 L_bo77
    s_waitcnt vmcnt(4)
L_bo77:
    s_waitcnt vmcnt(6)
    v_mfma_f32_16x16x32_bf16 v[20:23], v[12:15], v[176:179], v[20:23]
    v_and_b32_dpp v16, v24, v8 row_newbcast:11 row_mask:0xf bank_mask:0xf
    v_and_b32_dpp v17, v24, v9 row_newbcast:11 row_mask:0xf bank_mask:0xf
    v_and_b32_dpp v18, v24, v10 row_newbcast:11 row_mask:0xf bank_mask:0xf
    v_and_b32_dpp v19, v24, v11 row_newbcast:11 row_mask:0xf bank_mask:0xf
    buffer_load_dwordx4 v[176:179], v1, s[40:43], s56 offen offset:0 nt
    s_bitcmp1_b32 s52, 11
    s_cbranch_scc1 L_bo78
    s_waitcnt vmcnt(4)
L_bo78:
    s_waitcnt vmcnt(6)
    v_mfma_f32_16x16x32_bf16 v[20:23], v[16:19], v[180:183], v[20:23]
    v_and_b32_dpp v12, v24, v8 row_newbcast:7 row_mask:0xf bank_mask:0xf
    v_and_b32_dpp v13, v24, v9 row_newbcast:7 row_mask:0xf bank_mask:0xf
    v_and_b32_dpp v14, v24, v10 row_newbcast:7 row_mask:0xf bank_mask:0xf
    v_and_b32_dpp v15, v24, v11 row_newbcast:7 row_mask:0xf bank_mask:0xf
    buffer_load_dwordx4 v[180:183], v1, s[40:43], s56 offen offset:1024 nt
    s_bitcmp1_b32 s52, 12
    s_cbranch_scc1 L_bo79
    s_waitcnt vmcnt(4)
L_bo79:
    s_waitcnt vmcnt(6)
    v_mfma_f32_16x16x32_bf16 v[20:23], v[12:15], v[184:187], v[20:23]
    v_and_b32_dpp v16, v24, v8 row_newbcast:15 row_mask:0xf bank_mask:0xf
    v_and_b32_dpp v17, v24, v9 row_newbcast:15 row_mask:0xf bank_mask:0xf
    v_and_b32_dpp v18, v24, v10 row_newbcast:15 row_mask:0xf bank_mask:0xf
    v_and_b32_dpp v19, v24, v11 row_newbcast:15 row_mask:0xf bank_mask:0xf
    buffer_load_dwordx4 v[184:187], v1, s[40:43], s56 offen offset:2048 nt
    s_bitcmp1_b32 s52, 13
    s_cbranch_scc1 L_bo80
    s_waitcnt vmcnt(4)
L_bo80:
    s_waitcnt vmcnt(6)
    v_mfma_f32_16x16x32_bf16 v[20:23], v[16:19], v[188:191], v[20:23]
    v_and_b32_dpp v12, v25, v8 row_newbcast:0 row_mask:0xf bank_mask:0xf
    v_and_b32_dpp v13, v25, v9 row_newbcast:0 row_mask:0xf bank_mask:0xf
    v_and_b32_dpp v14, v25, v10 row_newbcast:0 row_mask:0xf bank_mask:0xf
    v_and_b32_dpp v15, v25, v11 row_newbcast:0 row_mask:0xf bank_mask:0xf
    buffer_load_dwordx4 v[188:191], v1, s[40:43], s56 offen offset:3072 nt
    s_add_u32 s56, s7, 0
    ds_add_rtn_u32 v106, v109, v104 offset:4
    s_bitcmp1_b32 s52, 14
    s_cbranch_scc1 L_bo81
    s_waitcnt vmcnt(4)
L_bo81:
    s_waitcnt vmcnt(6)
    v_mfma_f32_16x16x32_bf16 v[20:23], v[12:15], v[192:195], v[20:23]
    v_and_b32_dpp v16, v25, v8 row_newbcast:8 row_mask:0xf bank_mask:0xf
    v_and_b32_dpp v17, v25, v9 row_newbcast:8 row_mask:0xf bank_mask:0xf
    v_and_b32_dpp v18, v25, v10 row_newbcast:8 row_mask:0xf bank_mask:0xf
    v_and_b32_dpp v19, v25, v11 row_newbcast:8 row_mask:0xf bank_mask:0xf
    buffer_load_dwordx4 v[192:195], v1, s[40:43], s56 offen offset:0 nt
    ds_read_b32 v105, v109 offset:8
    s_bitcmp1_b32 s52, 15
    s_cbranch_scc1 L_bo82
    s_waitcnt vmcnt(4)
L_bo82:
    s_waitcnt vmcnt(6)
    v_mfma_f32_16x16x32_bf16 v[20:23], v[16:19], v[196:199], v[20:23]
    v_and_b32_dpp v12, v25, v8 row_newbcast:4 row_mask:0xf bank_mask:0xf
    v_and_b32_dpp v13, v25, v9 row_newbcast:4 row_mask:0xf bank_mask:0xf
    v_and_b32_dpp v14, v25, v10 row_newbcast:4 row_mask:0xf bank_mask:0xf
    v_and_b32_dpp v15, v25, v11 row_newbcast:4 row_mask:0xf bank_mask:0xf
    buffer_load_dwordx4 v[196:199], v1, s[40:43], s56 offen offset:1024 nt
    s_waitcnt lgkmcnt(0)
    v_readfirstlane_b32 s52, v105
    v_readfirstlane_b32 s60, v106
    s_lshr_b32 s52, s52, 1
    s_sub_i32 s60, s60, s53
    s_add_u32 s53, s53, 16
    s_max_i32 s60, s60, 0
    s_mul_i32 s60, s60, 3
    s_add_u32 s52, s52, s60
    s_min_u32 s52, s52, 16
    s_bfm_b32 s52, s52, 0
    s_bitcmp1_b32 s52, 0
    s_cbranch_scc1 L_bo83
    s_waitcnt vmcnt(4)
L_bo83:
    s_waitcnt vmcnt(6)
    v_mfma_f32_16x16x32_bf16 v[20:23], v[12:15], v[200:203], v[20:23]
    v_and_b32_dpp v16, v25, v8 row_newbcast:12 row_mask:0xf bank_mask:0xf
    v_and_b32_dpp v17, v25, v9 row_newbcast:12 row_mask:0xf bank_mask:0xf
    v_and_b32_dpp v18, v25, v10 row_newbcast:12 row_mask:0xf bank_mask:0xf
    v_and_b32_dpp v19, v25, v11 row_newbcast:12 row_mask:0xf bank_mask:0xf
    buffer_load_dwordx4 v[200:203], v1, s[40:43], s56 offen offset:2048 nt
    s_bitcmp1_b32 s52, 1
    s_cbranch_scc1 L_bo84
    s_waitcnt vmcnt(4)
L_bo84:
    s_waitcnt vmcnt(6)
    v_mfma_f32_16x16x32_bf16 v[20:23], v[16:19], v[204:207], v[20:23]
    v_and_b32_dpp v12, v25, v8 row_newbcast:1 row_mask:0xf bank_mask:0xf
    v_and_b32_dpp v13, v25, v9 row_newbcast:1 row_mask:0xf bank_mask:0xf
    v_and_b32_dpp v14, v25, v10 row_newbcast:1 row_mask:0xf bank_mask:0xf
    v_and_b32_dpp v15, v25, v11 row_newbcast:1 row_mask:0xf bank_mask:0xf
    buffer_load_dwordx4 v[204:207], v1, s[40:43], s56 offen offset:3072 nt
    s_add_u32 s56, s7, 65536
    ds_add_u32 v109, v104 offset:4
    s_bitcmp1_b32 s52, 2
    s_cbranch_scc1 L_bo85
    s_waitcnt vmcnt(4)
L_bo85:
    s_waitcnt vmcnt(6)
    v_mfma_f32_16x16x32_bf16 v[20:23], v[12:15], v[208:211], v[20:23]
    v_and_b32_dpp v16, v25, v8 row_newbcast:9 row_mask:0xf bank_mask:0xf
    v_and_b32_dpp v17, v25, v9 row_newbcast:9 row_mask:0xf bank_mask:0xf
    v_and_b32_dpp v18, v25, v10 row_newbcast:9 row_mask:0xf bank_mask:0xf
    v_and_b32_dpp v19, v25, v11 row_newbcast:9 row_mask:0xf bank_mask:0xf
    buffer_load_dwordx4 v[208:211], v1, s[40:43], s56 offen offset:0 nt
    s_bitcmp1_b32 s52, 3
    s_cbranch_scc1 L_bo86
    s_waitcnt vmcnt(4)
L_bo86:
    s_waitcnt vmcnt(6)
    v_mfma_f32_16x16x32_bf16 v[20:23], v[16:19], v[212:215], v[20:23]
    v_and_b32_dpp v12, v25, v8 row_newbcast:5 row_mask:0xf bank_mask:0xf
    v_and_b32_dpp v13, v25, v9 row_newbcast:5 row_mask:0xf bank_mask:0xf
    v_and_b32_dpp v14, v25, v10 row_newbcast:5 row_mask:0xf bank_mask:0xf
    v_and_b32_dpp v15, v25, v11 row_newbcast:5 row_mask:0xf bank_mask:0xf
    buffer_load_dwordx4 v[212:215], v1, s[40:43], s56 offen offset:1024 nt
    s_bitcmp1_b32 s52, 4
    s_cbranch_scc1 L_bo87
    s_waitcnt vmcnt(4)
L_bo87:
    s_waitcnt vmcnt(6)
    v_mfma_f32_16x16x32_bf16 v[20:23], v[12:15], v[216:219], v[20:23]
    v_and_b32_dpp v16, v25, v8 row_newbcast:13 row_mask:0xf bank_mask:0xf
    v_and_b32_dpp v17, v25, v9 row_newbcast:13 row_mask:0xf bank_mask:0xf
    v_and_b32_dpp v18, v25, v10 row_newbcast:13 row_mask:0xf bank_mask:0xf
    v_and_b32_dpp v19, v25, v11 row_newbcast:13 row_mask:0xf bank_mask:0xf
    buffer_load_dwordx4 v[216:219], v1, s[40:43], s56 offen offset:2048 nt
    s_bitcmp1_b32 s52, 5
    s_cbranch_scc1 L_bo88
    s_waitcnt vmcnt(4)
L_bo88:
    s_waitcnt vmcnt(6)
    v_mfma_f32_16x16x32_bf16 v[20:23], v[16:19], v[220:223], v[20:23]
    v_and_b32_dpp v12, v25, v8 row_newbcast:2 row_mask:0xf bank_mask:0xf
    v_and_b32_dpp v13, v25, v9 row_newbcast:2 row_mask:0xf bank_mask:0xf
    v_and_b32_dpp v14, v25, v10 row_newbcast:2 row_mask:0xf bank_mask:0xf
    v_and_b32_dpp v15, v25, v11 row_newbcast:2 row_mask:0xf bank_mask:0xf
    buffer_load_dwordx4 v[220:223], v1, s[40:43], s56 offen offset:3072 nt
    s_add_u32 s56, s7, 32768
    ds_add_u32 v109, v104 offset:4
    s_bitcmp1_b32 s52, 6
    s_cbranch_scc1 L_bo89
    s_waitcnt vmcnt(4)
L_bo89:
    s_waitcnt vmcnt(6)
    v_mfma_f32_16x16x32_bf16 v[20:23], v[12:15], v[224:227], v[20:23]
    v_and_b32_dpp v16, v25, v8 row_newbcast:10 row_mask:0xf bank_mask:0xf
    v_and_b32_dpp v17, v25, v9 row_newbcast:10 row_mask:0xf bank_mask:0xf
    v_and_b32_dpp v18, v25, v10 row_newbcast:10 row_mask:0xf bank_mask:0xf
    v_and_b32_dpp v19, v25, v11 row_newbcast:10 row_mask:0xf bank_mask:0xf
    buffer_load_dwordx4 v[224:227], v1, s[40:43], s56 offen offset:0 nt
    s_bitcmp1_b32 s52, 7
    s_cbranch_scc1 L_bo90
    s_waitcnt vmcnt(4)
L_bo90:
    s_waitcnt vmcnt(6)
    v_mfma_f32_16x16x32_bf16 v[20:23], v[16:19], v[228:231], v[20:23]
    v_and_b32_dpp v12, v25, v8 row_newbcast:6 row_mask:0xf bank_mask:0xf
    v_and_b32_dpp v13, v25, v9 row_newbcast:6 row_mask:0xf bank_mask:0xf
    v_and_b32_dpp v14, v25, v10 row_newbcast:6 row_mask:0xf bank_mask:0xf
    v_and_b32_dpp v15, v25, v11 row_newbcast:6 row_mask:0xf bank_mask:0xf
    buffer_load_dwordx4 v[228:231], v1, s[40:43], s56 offen offset:1024 nt
    s_bitcmp1_b32 s52, 8
    s_cbranch_scc1 L_bo91
    s_waitcnt vmcnt(4)
L_bo91:
    s_waitcnt vmcnt(6)
    v_mfma_f32_16x16x32_bf16 v[20:23], v[12:15], v[232:235], v[20:23]
    v_and_b32_dpp v16, v25, v8 row_newbcast:14 row_mask:0xf bank_mask:0xf
    v_and_b32_dpp v17, v25, v9 row_newbcast:14 row_mask:0xf bank_mask:0xf
    v_and_b32_dpp v18, v25, v10 row_newbcast:14 row_mask:0xf bank_mask:0xf
    v_and_b32_dpp v19, v25, v11 row_newbcast:14 row_mask:0xf bank_mask:0xf
    buffer_load_dwordx4 v[232:235], v1, s[40:43], s56 offen offset:2048 nt
    s_bitcmp1_b32 s52, 9
    s_cbranch_scc1 L_bo92
    s_waitcnt vmcnt(4)
L_bo92:
    s_waitcnt vmcnt(6)
    v_mfma_f32_16x16x32_bf16 v[20:23], v[16:19], v[236:239], v[20:23]
    v_and_b32_dpp v12, v25, v8 row_newbcast:3 row_mask:0xf bank_mask:0xf
    v_and_b32_dpp v13, v25, v9 row_newbcast:3 row_mask:0xf bank_mask:0xf
    v_and_b32_dpp v14, v25, v10 row_newbcast:3 row_mask:0xf bank_mask:0xf
    v_and_b32_dpp v15, v25, v11 row_newbcast:3 row_mask:0xf bank_mask:0xf
    buffer_load_dwordx4 v[236:239], v1, s[40:43], s56 offen offset:3072 nt
    s_add_u32 s56, s7, 98304
    ds_add_u32 v109, v104 offset:4
    s_bitcmp1_b32 s52, 10
    s_cbranch_scc1 L_bo93
    s_waitcnt vmcnt(4)
L_bo93:
    s_waitcnt vmcnt(6)
    v_mfma_f32_16x16x32_bf16 v[20:23], v[12:15], v[240:243], v[20:23]
    v_and_b32_dpp v16, v25, v8 row_newbcast:11 row_mask:0xf bank_mask:0xf
    v_and_b32_dpp v17, v25, v9 row_newbcast:11 row_mask:0xf bank_mask:0xf
    v_and_b32_dpp v18, v25, v10 row_newbcast:11 row_mask:0xf bank_mask:0xf
    v_and_b32_dpp v19, v25, v11 row_newbcast:11 row_mask:0xf bank_mask:0xf
    buffer_load_dwordx4 v[240:243], v1, s[40:43], s56 offen offset:0 nt
    s_bitcmp1_b32 s52, 11
    s_cbranch_scc1 L_bo94
    s_waitcnt vmcnt(4)
L_bo94:
    s_waitcnt vmcnt(6)
    v_mfma_f32_16x16x32_bf16 v[20:23], v[16:19], v[244:247], v[20:23]
    v_and_b32_dpp v12, v25, v8 row_newbcast:7 row_mask:0xf bank_mask:0xf
    v_and_b32_dpp v13, v25, v9 row_newbcast:7 row_mask:0xf bank_mask:0xf
    v_and_b32_dpp v14, v25, v10 row_newbcast:7 row_mask:0xf bank_mask:0xf
    v_and_b32_dpp v15, v25, v11 row_newbcast:7 row_mask:0xf bank_mask:0xf
    buffer_load_dwordx4 v[244:247], v1, s[40:43], s56 offen offset:1024 nt
    s_bitcmp1_b32 s52, 12
    s_cbranch_scc1 L_bo95
    s_waitcnt vmcnt(4)
L_bo95:
    s_waitcnt vmcnt(6)
    v_mfma_f32_16x16x32_bf16 v[20:23], v[12:15], v[248:251], v[20:23]
    v_and_b32_dpp v16, v25, v8 row_newbcast:15 row_mask:0xf bank_mask:0xf
    v_and_b32_dpp v17, v25, v9 row_newbcast:15 row_mask:0xf bank_mask:0xf
    v_and_b32_dpp v18, v25, v10 row_newbcast:15 row_mask:0xf bank_mask:0xf
    v_and_b32_dpp v19, v25, v11 row_newbcast:15 row_mask:0xf bank_mask:0xf
    buffer_load_dwordx4 v[248:251], v1, s[40:43], s56 offen offset:2048 nt
    s_bitcmp1_b32 s52, 13
    s_cbranch_scc1 L_bo96
    s_waitcnt vmcnt(5)
L_bo96:
    s_waitcnt vmcnt(7)
    v_mfma_f32_16x16x32_bf16 v[20:23], v[16:19], v[252:255], v[20:23]
    buffer_load_dwordx4 v[252:255], v1, s[40:43], s56 offen offset:3072 nt
    s_add_u32 s70, s70, 131072
    s_xor_b32 s6, s70, s71
    s_xor_b32 s7, s6, 16384
    s_add_u32 s56, s6, 0
    s_sub_u32 s57, s57, 1
    s_cmp_lg_u32 s57, 0
    s_cbranch_scc1 L_v
    v_lshlrev_b32 v24, 16, v32
    v_and_b32 v25, 0xffff0000, v32
    v_sub_f32 v24, v24, v28
    v_sub_f32 v25, v25, v28
    v_mul_f32 v24, 0x3fb8aa3b, v24
    v_mul_f32 v25, 0x3fb8aa3b, v25
    v_exp_f32 v24, v24
    v_exp_f32 v25, v25
    s_nop 0
    v_cvt_pk_bf16_f32 v24, v24, v24
    v_cvt_pk_bf16_f32 v25, v25, v25
    s_nop 0
    v_and_b32_dpp v12, v24, v8 row_newbcast:0 row_mask:0xf bank_mask:0xf
    v_and_b32_dpp v13, v24, v9 row_newbcast:0 row_mask:0xf bank_mask:0xf
    v_and_b32_dpp v14, v24, v10 row_newbcast:0 row_mask:0xf bank_mask:0xf
    v_and_b32_dpp v15, v24, v11 row_newbcast:0 row_mask:0xf bank_mask:0xf
    s_nop 0
    s_waitcnt vmcnt(31)
    v_mfma_f32_16x16x32_bf16 v[20:23], v[12:15], v[128:131], v[20:23]
    v_and_b32_dpp v16, v24, v8 row_newbcast:8 row_mask:0xf bank_mask:0xf
    v_and_b32_dpp v17, v24, v9 row_newbcast:8 row_mask:0xf bank_mask:0xf
    v_and_b32_dpp v18, v24, v10 row_newbcast:8 row_mask:0xf bank_mask:0xf
    v_and_b32_dpp v19, v24, v11 row_newbcast:8 row_mask:0xf bank_mask:0xf
    s_nop 0
    s_waitcnt vmcnt(30)
    v_mfma_f32_16x16x32_bf16 v[20:23], v[16:19], v[132:135], v[20:23]
    v_and_b32_dpp v12, v24, v8 row_newbcast:4 row_mask:0xf bank_mask:0xf
    v_and_b32_dpp v13, v24, v9 row_newbcast:4 row_mask:0xf bank_mask:0xf
    v_and_b32_dpp v14, v24, v10 row_newbcast:4 row_mask:0xf bank_mask:0xf
    v_and_b32_dpp v15, v24, v11 row_newbcast:4 row_mask:0xf bank_mask:0xf
    s_nop 0
    s_waitcnt vmcnt(29)
    v_mfma_f32_16x16x32_bf16 v[20:23], v[12:15], v[136:139], v[20:23]
    v_and_b32_dpp v16, v24, v8 row_newbcast:12 row_mask:0xf bank_mask:0xf
    v_and_b32_dpp v17, v24, v9 row_newbcast:12 row_mask:0xf bank_mask:0xf
    v_and_b32_dpp v18, v24, v10 row_newbcast:12 row_mask:0xf bank_mask:0xf
    v_and_b32_dpp v19, v24, v11 row_newbcast:12 row_mask:0xf bank_mask:0xf
    s_nop 0
    s_waitcnt vmcnt(28)
    v_mfma_f32_16x16x32_bf16 v[20:23], v[16:19], v[140:143], v[20:23]
    v_and_b32_dpp v12, v24, v8 row_newbcast:1 row_mask:0xf bank_mask:0xf
    v_and_b32_dpp v13, v24, v9 row_newbcast:1 row_mask:0xf bank_mask:0xf
    v_and_b32_dpp v14, v24, v10 row_newbcast:1 row_mask:0xf bank_mask:0xf
    v_and_b32_dpp v15, v24, v11 row_newbcast:1 row_mask:0xf bank_mask:0xf
    s_nop 0
    s_waitcnt vmcnt(27)
    v_mfma_f32_16x16x32_bf16 v[20:23], v[12:15], v[144:147], v[20:23]
    v_and_b32_dpp v16, v24, v8 row_newbcast:9 row_mask:0xf bank_mask:0xf
    v_and_b32_dpp v17, v24, v9 row_newbcast:9 row_mask:0xf bank_mask:0xf
    v_and_b32_dpp v18, v24, v10 row_newbcast:9 row_mask:0xf bank_mask:0xf
    v_and_b32_dpp v19, v24, v11 row_newbcast:9 row_mask:0xf bank_mask:0xf
    s_nop 0
    s_waitcnt vmcnt(26)
    v_mfma_f32_16x16x32_bf16 v[20:23], v[16:19], v[148:151], v[20:23]
    v_and_b32_dpp v12, v24, v8 row_newbcast:5 row_mask:0xf bank_mask:0xf
    v_and_b32_dpp v13, v24, v9 row_newbcast:5 row_mask:0xf bank_mask:0xf
    v_and_b32_dpp v14, v24, v10 row_newbcast:5 row_mask:0xf bank_mask:0xf
    v_and_b32_dpp v15, v24, v11 row_newbcast:5 row_mask:0xf bank_mask:0xf
    s_nop 0
    s_waitcnt vmcnt(25)
    v_mfma_f32_16x16x32_bf16 v[20:23], v[12:15], v[152:155], v[20:23]
    v_and_b32_dpp v16, v24, v8 row_newbcast:13 row_mask:0xf bank_mask:0xf
    v_and_b32_dpp v17, v24, v9 row_newbcast:13 row_mask:0xf bank_mask:0xf
    v_and_b32_dpp v18, v24, v10 row_newbcast:13 row_mask:0xf bank_mask:0xf
    v_and_b32_dpp v19, v24, v11 row_newbcast:13 row_mask:0xf bank_mask:0xf
    s_nop 0
    s_waitcnt vmcnt(24)
    v_mfma_f32_16x16x32_bf16 v[20:23], v[16:19], v[156:159], v[20:23]
    v_and_b32_dpp v12, v24, v8 row_newbcast:2 row_mask:0xf bank_mask:0xf
    v_and_b32_dpp v13, v24, v9 row_newbcast:2 row_mask:0xf bank_mask:0xf
    v_and_b32_dpp v14, v24, v10 row_newbcast:2 row_mask:0xf bank_mask:0xf
    v_and_b32_dpp v15, v24, v11 row_newbcast:2 row_mask:0xf bank_mask:0xf
    s_nop 0
    s_waitcnt vmcnt(23)
    v_mfma_f32_16x16x32_bf16 v[20:23], v[12:15], v[160:163], v[20:23]
    v_and_b32_dpp v16, v24, v8 row_newbcast:10 row_mask:0xf bank_mask:0xf
    v_and_b32_dpp v17, v24, v9 row_newbcast:10 row_mask:0xf bank_mask:0xf
    v_and_b32_dpp v18, v24, v10 row_newbcast:10 row_mask:0xf bank_mask:0xf
    v_and_b32_dpp v19, v24, v11 row_newbcast:10 row_mask:0xf bank_mask:0xf
    s_nop 0
    s_waitcnt vmcnt(22)
    v_mfma_f32_16x16x32_bf16 v[20:23], v[16:19], v[164:167], v[20:23]
    v_and_b32_dpp v12, v24, v8 row_newbcast:6 row_mask:0xf bank_mask:0xf
    v_and_b32_dpp v13, v24, v9 row_newbcast:6 row_mask:0xf bank_mask:0xf
    v_and_b32_dpp v14, v24, v10 row_newbcast:6 row_mask:0xf bank_mask:0xf
    v_and_b32_dpp v15, v24, v11 row_newbcast:6 row_mask:0xf bank_mask:0xf
    s_nop 0
    s_waitcnt vmcnt(21)
    v_mfma_f32_16x16x32_bf16 v[20:23], v[12:15], v[168:171], v[20:23]
    v_and_b32_dpp v16, v24, v8 row_newbcast:14 row_mask:0xf bank_mask:0xf
    v_and_b32_dpp v17, v24, v9 row_newbcast:14 row_mask:0xf bank_mask:0xf
    v_and_b32_dpp v18, v24, v10 row_newbcast:14 row_mask:0xf bank_mask:0xf
    v_and_b32_dpp v19, v24, v11 row_newbcast:14 row_mask:0xf bank_mask:0xf
    s_nop 0
    s_waitcnt vmcnt(20)
    v_mfma_f32_16x16x32_bf16 v[20:23], v[16:19], v[172:175], v[20:23]
    v_and_b32_dpp v12, v24, v8 row_newbcast:3 row_mask:0xf bank_mask:0xf
    v_and_b32_dpp v13, v24, v9 row_newbcast:3 row_mask:0xf bank_mask:0xf
    v_and_b32_dpp v14, v24, v10 row_newbcast:3 row_mask:0xf bank_mask:0xf
    v_and_b32_dpp v15, v24, v11 row_newbcast:3 row_mask:0xf bank_mask:0xf
    s_nop 0
    s_waitcnt vmcnt(19)
    v_mfma_f32_16x16x32_bf16 v[20:23], v[12:15], v[176:179], v[20:23]
    v_and_b32_dpp v16, v24, v8 row_newbcast:11 row_mask:0xf bank_mask:0xf
    v_and_b32_dpp v17, v24, v9 row_newbcast:11 row_mask:0xf bank_mask:0xf
    v_and_b32_dpp v18, v24, v10 row_newbcast:11 row_mask:0xf bank_mask:0xf
    v_and_b32_dpp v19, v24, v11 row_newbcast:11 row_mask:0xf bank_mask:0xf
    s_nop 0
    s_waitcnt vmcnt(18)
    v_mfma_f32_16x16x32_bf16 v[20:23], v[16:19], v[180:183], v[20:23]
    v_and_b32_dpp v12, v24, v8 row_newbcast:7 row_mask:0xf bank_mask:0xf
    v_and_b32_dpp v13, v24, v9 row_newbcast:7 row_mask:0xf bank_mask:0xf
    v_and_b32_dpp v14, v24, v10 row_newbcast:7 row_mask:0xf bank_mask:0xf
    v_and_b32_dpp v15, v24, v11 row_newbcast:7 row_mask:0xf bank_mask:0xf
    s_nop 0
    s_waitcnt vmcnt(17)
    v_mfma_f32_16x16x32_bf16 v[20:23], v[12:15], v[184:187], v[20:23]
    v_and_b32_dpp v16, v24, v8 row_newbcast:15 row_mask:0xf bank_mask:0xf
    v_and_b32_dpp v17, v24, v9 row_newbcast:15 row_mask:0xf bank_mask:0xf
    v_and_b32_dpp v18, v24, v10 row_newbcast:15 row_mask:0xf bank_mask:0xf
    v_and_b32_dpp v19, v24, v11 row_newbcast:15 row_mask:0xf bank_mask:0xf
    s_nop 0
    s_waitcnt vmcnt(16)
    v_mfma_f32_16x16x32_bf16 v[20:23], v[16:19], v[188:191], v[20:23]
    v_and_b32_dpp v12, v25, v8 row_newbcast:0 row_mask:0xf bank_mask:0xf
    v_and_b32_dpp v13, v25, v9 row_newbcast:0 row_mask:0xf bank_mask:0xf
    v_and_b32_dpp v14, v25, v10 row_newbcast:0 row_mask:0xf bank_mask:0xf
    v_and_b32_dpp v15, v25, v11 row_newbcast:0 row_mask:0xf bank_mask:0xf
    s_nop 0
    s_waitcnt vmcnt(15)
    v_mfma_f32_16x16x32_bf16 v[20:23], v[12:15], v[192:195], v[20:23]
    v_and_b32_dpp v16, v25, v8 row_newbcast:8 row_mask:0xf bank_mask:0xf
    v_and_b32_dpp v17, v25, v9 row_newbcast:8 row_mask:0xf bank_mask:0xf
    v_and_b32_dpp v18, v25, v10 row_newbcast:8 row_mask:0xf bank_mask:0xf
    v_and_b32_dpp v19, v25, v11 row_newbcast:8 row_mask:0xf bank_mask:0xf
    s_nop 0
    s_waitcnt vmcnt(14)
    v_mfma_f32_16x16x32_bf16 v[20:23], v[16:19], v[196:199], v[20:23]
    v_and_b32_dpp v12, v25, v8 row_newbcast:4 row_mask:0xf bank_mask:0xf
    v_and_b32_dpp v13, v25, v9 row_newbcast:4 row_mask:0xf bank_mask:0xf
    v_and_b32_dpp v14, v25, v10 row_newbcast:4 row_mask:0xf bank_mask:0xf
    v_and_b32_dpp v15, v25, v11 row_newbcast:4 row_mask:0xf bank_mask:0xf
    s_nop 0
    s_waitcnt vmcnt(13)
    v_mfma_f32_16x16x32_bf16 v[20:23], v[12:15], v[200:203], v[20:23]
    v_and_b32_dpp v16, v25, v8 row_newbcast:12 row_mask:0xf bank_mask:0xf
    v_and_b32_dpp v17, v25, v9 row_newbcast:12 row_mask:0xf bank_mask:0xf
    v_and_b32_dpp v18, v25, v10 row_newbcast:12 row_mask:0xf bank_mask:0xf
    v_and_b32_dpp v19, v25, v11 row_newbcast:12 row_mask:0xf bank_mask:0xf
    s_nop 0
    s_waitcnt vmcnt(12)
    v_mfma_f32_16x16x32_bf16 v[20:23], v[16:19], v[204:207], v[20:23]
    v_and_b32_dpp v12, v25, v8 row_newbcast:1 row_mask:0xf bank_mask:0xf
    v_and_b32_dpp v13, v25, v9 row_newbcast:1 row_mask:0xf bank_mask:0xf
    v_and_b32_dpp v14, v25, v10 row_newbcast:1 row_mask:0xf bank_mask:0xf
    v_and_b32_dpp v15, v25, v11 row_newbcast:1 row_mask:0xf bank_mask:0xf
    s_nop 0
    s_waitcnt vmcnt(11)
    v_mfma_f32_16x16x32_bf16 v[20:23], v[12:15], v[208:211], v[20:23]
    v_and_b32_dpp v16, v25, v8 row_newbcast:9 row_mask:0xf bank_mask:0xf
    v_and_b32_dpp v17, v25, v9 row_newbcast:9 row_mask:0xf bank_mask:0xf
    v_and_b32_dpp v18, v25, v10 row_newbcast:9 row_mask:0xf bank_mask:0xf
    v_and_b32_dpp v19, v25, v11 row_newbcast:9 row_mask:0xf bank_mask:0xf
    s_nop 0
    s_waitcnt vmcnt(10)
    v_mfma_f32_16x16x32_bf16 v[20:23], v[16:19], v[212:215], v[20:23]
    v_and_b32_dpp v12, v25, v8 row_newbcast:5 row_mask:0xf bank_mask:0xf
    v_and_b32_dpp v13, v25, v9 row_newbcast:5 row_mask:0xf bank_mask:0xf
    v_and_b32_dpp v14, v25, v10 row_newbcast:5 row_mask:0xf bank_mask:0xf
    v_and_b32_dpp v15, v25, v11 row_newbcast:5 row_mask:0xf bank_mask:0xf
    s_nop 0
    s_waitcnt vmcnt(9)
    v_mfma_f32_16x16x32_bf16 v[20:23], v[12:15], v[216:219], v[20:23]
    v_and_b32_dpp v16, v25, v8 row_newbcast:13 row_mask:0xf bank_mask:0xf
    v_and_b32_dpp v17, v25, v9 row_newbcast:13 row_mask:0xf bank_mask:0xf
    v_and_b32_dpp v18, v25, v10 row_newbcast:13 row_mask:0xf bank_mask:0xf
    v_and_b32_dpp v19, v25, v11 row_newbcast:13 row_mask:0xf bank_mask:0xf
    s_nop 0
    s_waitcnt vmcnt(8)
    v_mfma_f32_16x16x32_bf16 v[20:23], v[16:19], v[220:223], v[20:23]
    v_and_b32_dpp v12, v25, v8 row_newbcast:2 row_mask:0xf bank_mask:0xf
    v_and_b32_dpp v13, v25, v9 row_newbcast:2 row_mask:0xf bank_mask:0xf
    v_and_b32_dpp v14, v25, v10 row_newbcast:2 row_mask:0xf bank_mask:0xf
    v_and_b32_dpp v15, v25, v11 row_newbcast:2 row_mask:0xf bank_mask:0xf
    s_nop 0
    s_waitcnt vmcnt(7)
    v_mfma_f32_16x16x32_bf16 v[20:23], v[12:15], v[224:227], v[20:23]
    v_and_b32_dpp v16, v25, v8 row_newbcast:10 row_mask:0xf bank_mask:0xf
    v_and_b32_dpp v17, v25, v9 row_newbcast:10 row_mask:0xf bank_mask:0xf
    v_and_b32_dpp v18, v25, v10 row_newbcast:10 row_mask:0xf bank_mask:0xf
    v_and_b32_dpp v19, v25, v11 row_newbcast:10 row_mask:0xf bank_mask:0xf
    s_nop 0
    s_waitcnt vmcnt(6)
    v_mfma_f32_16x16x32_bf16 v[20:23], v[16:19], v[228:231], v[20:23]
    v_and_b32_dpp v12, v25, v8 row_newbcast:6 row_mask:0xf bank_mask:0xf
    v_and_b32_dpp v13, v25, v9 row_newbcast:6 row_mask:0xf bank_mask:0xf
    v_and_b32_dpp v14, v25, v10 row_newbcast:6 row_mask:0xf bank_mask:0xf
    v_and_b32_dpp v15, v25, v11 row_newbcast:6 row_mask:0xf bank_mask:0xf
    s_nop 0
    s_waitcnt vmcnt(5)
    v_mfma_f32_16x16x32_bf16 v[20:23], v[12:15], v[232:235], v[20:23]
    v_and_b32_dpp v16, v25, v8 row_newbcast:14 row_mask:0xf bank_mask:0xf
    v_and_b32_dpp v17, v25, v9 row_newbcast:14 row_mask:0xf bank_mask:0xf
    v_and_b32_dpp v18, v25, v10 row_newbcast:14 row_mask:0xf bank_mask:0xf
    v_and_b32_dpp v19, v25, v11 row_newbcast:14 row_mask:0xf bank_mask:0xf
    s_nop 0
    s_waitcnt vmcnt(4)
    v_mfma_f32_16x16x32_bf16 v[20:23], v[16:19], v[236:239], v[20:23]
    v_and_b32_dpp v12, v25, v8 row_newbcast:3 row_mask:0xf bank_mask:0xf
    v_and_b32_dpp v13, v25, v9 row_newbcast:3 row_mask:0xf bank_mask:0xf
    v_and_b32_dpp v14, v25, v10 row_newbcast:3 row_mask:0xf bank_mask:0xf
    v_and_b32_dpp v15, v25, v11 row_newbcast:3 row_mask:0xf bank_mask:0xf
    s_nop 0
    s_waitcnt vmcnt(3)
    v_mfma_f32_16x16x32_bf16 v[20:23], v[12:15], v[240:243], v[20:23]
    v_and_b32_dpp v16, v25, v8 row_newbcast:11 row_mask:0xf bank_mask:0xf
    v_and_b32_dpp v17, v25, v9 row_newbcast:11 row_mask:0xf bank_mask:0xf
    v_and_b32_dpp v18, v25, v10 row_newbcast:11 row_mask:0xf bank_mask:0xf
    v_and_b32_dpp v19, v25, v11 row_newbcast:11 row_mask:0xf bank_mask:0xf
    s_nop 0
    s_waitcnt vmcnt(2)
    v_mfma_f32_16x16x32_bf16 v[20:23], v[16:19], v[244:247], v[20:23]
    v_and_b32_dpp v12, v25, v8 row_newbcast:7 row_mask:0xf bank_mask:0xf
    v_and_b32_dpp v13, v25, v9 row_newbcast:7 row_mask:0xf bank_mask:0xf
    v_and_b32_dpp v14, v25, v10 row_newbcast:7 row_mask:0xf bank_mask:0xf
    v_and_b32_dpp v15, v25, v11 row_newbcast:7 row_mask:0xf bank_mask:0xf
    s_nop 0
    s_waitcnt vmcnt(1)
    v_mfma_f32_16x16x32_bf16 v[20:23], v[12:15], v[248:251], v[20:23]
    v_and_b32_dpp v16, v25, v8 row_newbcast:15 row_mask:0xf bank_mask:0xf
    v_and_b32_dpp v17, v25, v9 row_newbcast:15 row_mask:0xf bank_mask:0xf
    v_and_b32_dpp v18, v25, v10 row_newbcast:15 row_mask:0xf bank_mask:0xf
    v_and_b32_dpp v19, v25, v11 row_newbcast:15 row_mask:0xf bank_mask:0xf
    s_nop 0
    s_waitcnt vmcnt(0)
    v_mfma_f32_16x16x32_bf16 v[20:23], v[16:19], v[252:255], v[20:23]
    s_nop 7
    v_cvt_pk_bf16_f32 v20, v20, v21
    v_cvt_pk_bf16_f32 v21, v22, v23
    ds_write2_b32 v2, v20, v21 offset0:0 offset1:160
    s_waitcnt lgkmcnt(0)
    s_barrier
    s_setprio 0
    s_mul_i32 s61, s35, 4
    s_add_u32 s61, s61, s4
    s_cmp_ge_u32 s61, 18
    s_cbranch_scc1 L_send
    v_and_b32 v122, 7, v0
    v_lshrrev_b32 v123, 3, v0
    s_lshl_b32 s58, s61, 5
    v_lshlrev_b32 v114, 2, v122
    v_add_u32 v114, s58, v114
    v_lshlrev_b32 v116, 1, v114
    v_lshl_add_u32 v116, v123, 16, v116
    v_mul_u32_u24 v124, 18432, v123
    v_lshl_add_u32 v124, v114, 2, v124
    v_mul_u32_u24 v115, 2304, v123
    v_lshl_add_u32 v115, v122, 4, v115
    s_mul_i32 s58, s34, 73728
    s_lshl_b32 s59, s61, 7
    s_add_u32 s58, s58, s59
    v_add_u32 v115, s58, v115
    v_bfe_u32 v120, v0, 5, 1
    v_bfe_u32 v121, v0, 4, 1
    v_lshl_add_u32 v120, v121, 1, v120
    v_add_u32 v114, v114, v120
    v_lshlrev_b32 v114, 1, v114
    s_mul_i32 s58, s34, 1152
    s_add_u32 s44, s8, s58
    s_addc_u32 s45, s9, 0
    s_and_b32 s45, s45, 0xffff
    s_mov_b32 s46, 1152
    s_mov_b32 s47, 0x20000
    buffer_load_ushort v113, v114, s[44:47], 0 offen
    s_mov_b32 s48, s26
    s_and_b32 s49, s27, 0xffff
    s_mov_b32 s50, 1152
    s_mov_b32 s51, 0x20000
    buffer_load_ushort v112, v114, s[48:51], 0 offen
    s_add_u32 s44, s28, s58
    s_addc_u32 s45, s29, 0
    s_and_b32 s45, s45, 0xffff
    s_mov_b32 s46, 1152
    s_mov_b32 s47, 0x20000
    s_mul_i32 s58, s34, 2304
    s_add_u32 s58, s58, 589824
    v_add_u32 v117, s58, v124
    s_mov_b32 s48, s32
    s_and_b32 s49, s33, 0xffff
    s_mov_b32 s50, 835584
    s_mov_b32 s51, 0x20000
    s_mov_b32 s58, 18432
    s_mov_b32 s59, 36864
    s_mov_b32 s60, 55296
    s_mov_b32 s74, 0x200000
    s_barrier
    buffer_load_dwordx4 v[128:131], v115, s[48:51], 0 offen sc1
    buffer_load_dwordx4 v[132:135], v115, s[48:51], s58 offen sc1
    buffer_load_dwordx4 v[136:139], v115, s[48:51], s59 offen sc1
    buffer_load_dwordx4 v[140:143], v115, s[48:51], s60 offen sc1
    buffer_load_dwordx4 v[144:147], v117, s[48:51], 0 offen sc1
    s_sleep 1
    buffer_load_dwordx4 v[148:151], v115, s[48:51], 0 offen sc1
    buffer_load_dwordx4 v[152:155], v115, s[48:51], s58 offen sc1
    buffer_load_dwordx4 v[156:159], v115, s[48:51], s59 offen sc1
    buffer_load_dwordx4 v[160:163], v115, s[48:51], s60 offen sc1
    buffer_load_dwordx4 v[164:167], v117, s[48:51], 0 offen sc1
    s_sleep 1
    s_waitcnt vmcnt(10)
    v_lshlrev_b32 v113, 16, v113
    v_lshlrev_b32 v112, 16, v112
L_fin_poll:
    buffer_load_dwordx4 v[168:171], v115, s[48:51], 0 offen sc1
    buffer_load_dwordx4 v[172:175], v115, s[48:51], s58 offen sc1
    buffer_load_dwordx4 v[176:179], v115, s[48:51], s59 offen sc1
    buffer_load_dwordx4 v[180:183], v115, s[48:51], s60 offen sc1
    buffer_load_dwordx4 v[184:187], v117, s[48:51], 0 offen sc1
    s_waitcnt vmcnt(10)
    v_max_u32 v24, v128, v129
    v_max3_u32 v24, v24, v130, v131
    v_max3_u32 v24, v24, v132, v133
    v_max3_u32 v24, v24, v134, v135
    v_max3_u32 v24, v24, v136, v137
    v_max3_u32 v24, v24, v138, v139
    v_max3_u32 v24, v24, v140, v141
    v_max3_u32 v24, v24, v142, v143
    v_max3_u32 v24, v24, v144, v145
    v_max3_u32 v24, v24, v146, v147
    v_cmp_eq_u32 vcc, -1, v24
    v_permlane32_swap_b32 v144, v145
    v_permlane32_swap_b32 v146, v147
    v_add_f32 v72, v128, v132
    v_add_f32 v76, v136, v140
    v_add_f32 v73, v129, v133
    v_add_f32 v77, v137, v141
    v_add_f32 v74, v130, v134
    v_add_f32 v78, v138, v142
    v_add_f32 v75, v131, v135
    v_add_f32 v79, v139, v143
    v_add_f32 v80, v144, v145
    v_add_f32 v81, v146, v147
    s_cbranch_vccz L_fin_go
    s_sleep 1
    buffer_load_dwordx4 v[128:131], v115, s[48:51], 0 offen sc1
    buffer_load_dwordx4 v[132:135], v115, s[48:51], s58 offen sc1
    buffer_load_dwordx4 v[136:139], v115, s[48:51], s59 offen sc1
    buffer_load_dwordx4 v[140:143], v115, s[48:51], s60 offen sc1
    buffer_load_dwordx4 v[144:147], v117, s[48:51], 0 offen sc1
    s_waitcnt vmcnt(10)
    v_max_u32 v24, v148, v149
    v_max3_u32 v24, v24, v150, v151
    v_max3_u32 v24, v24, v152, v153
    v_max3_u32 v24, v24, v154, v155
    v_max3_u32 v24, v24, v156, v157
    v_max3_u32 v24, v24, v158, v159
    v_max3_u32 v24, v24, v160, v161
    v_max3_u32 v24, v24, v162, v163
    v_max3_u32 v24, v24, v164, v165
    v_max3_u32 v24, v24, v166, v167
    v_cmp_eq_u32 vcc, -1, v24
    v_permlane32_swap_b32 v164, v165
    v_permlane32_swap_b32 v166, v167
    v_add_f32 v72, v148, v152
    v_add_f32 v76, v156, v160
    v_add_f32 v73, v149, v153
    v_add_f32 v77, v157, v161
    v_add_f32 v74, v150, v154
    v_add_f32 v78, v158, v162
    v_add_f32 v75, v151, v155
    v_add_f32 v79, v159, v163
    v_add_f32 v80, v164, v165
    v_add_f32 v81, v166, v167
    s_cbranch_vccz L_fin_go
    s_sleep 1
    buffer_load_dwordx4 v[148:151], v115, s[48:51], 0 offen sc1
    buffer_load_dwordx4 v[152:155], v115, s[48:51], s58 offen sc1
    buffer_load_dwordx4 v[156:159], v115, s[48:51], s59 offen sc1
    buffer_load_dwordx4 v[160:163], v115, s[48:51], s60 offen sc1
    buffer_load_dwordx4 v[164:167], v117, s[48:51], 0 offen sc1
    s_waitcnt vmcnt(10)
    v_max_u32 v24, v168, v169
    v_max3_u32 v24, v24, v170, v171
    v_max3_u32 v24, v24, v172, v173
    v_max3_u32 v24, v24, v174, v175
    v_max3_u32 v24, v24, v176, v177
    v_max3_u32 v24, v24, v178, v179
    v_max3_u32 v24, v24, v180, v181
    v_max3_u32 v24, v24, v182, v183
    v_max3_u32 v24, v24, v184, v185
    v_max3_u32 v24, v24, v186, v187
    v_cmp_eq_u32 vcc, -1, v24
    v_permlane32_swap_b32 v184, v185
    v_permlane32_swap_b32 v186, v187
    v_add_f32 v72, v168, v172
    v_add_f32 v76, v176, v180
    v_add_f32 v73, v169, v173
    v_add_f32 v77, v177, v181
    v_add_f32 v74, v170, v174
    v_add_f32 v78, v178, v182
    v_add_f32 v75, v171, v175
    v_add_f32 v79, v179, v183
    v_add_f32 v80, v184, v185
    v_add_f32 v81, v186, v187
    s_cbranch_vccz L_fin_go
    s_sleep 1
    s_sub_u32 s74, s74, 1
    s_cmp_lg_u32 s74, 0
    s_cbranch_scc1 L_fin_poll
L_fin_go:
    v_add_f32 v72, v72, v76
    v_add_f32 v73, v73, v77
    v_add_f32 v74, v74, v78
    v_add_f32 v75, v75, v79
    v_permlane16_swap_b32 v80, v81
    v_permlane32_swap_b32 v72, v73
    v_add_f32 v80, v80, v81
    v_permlane32_swap_b32 v74, v75
    v_add_f32 v72, v72, v73
    v_add_f32_dpp v80, v80, v80 row_ror:8 row_mask:0xf bank_mask:0xf
    v_add_f32 v74, v74, v75
    v_cvt_pk_bf16_f32 v80, v80, v80
    v_and_b32 v80, 0xffff0000, v80
    v_permlane16_swap_b32 v72, v74
    v_add_f32 v80, v80, v112
    v_add_f32 v72, v72, v74
    v_cvt_pk_bf16_f32 v80, v80, v80
    v_and_b32 v80, 0xffff0000, v80
    v_mul_f32 v24, 0xbfb8aa3b, v80
    v_exp_f32 v24, v24
    v_add_f32_dpp v72, v72, v72 row_ror:8 row_mask:0xf bank_mask:0xf
    v_add_f32 v24, 1.0, v24
    v_rcp_f32 v24, v24
    v_cvt_pk_bf16_f32 v72, v72, v72
    v_and_b32 v72, 0xffff0000, v72
    v_mul_f32 v80, v80, v24
    v_cvt_pk_bf16_f32 v80, v80, v80
    v_and_b32 v80, 0xffff0000, v80
    v_mul_f32 v72, v72, v80
    v_cvt_pk_bf16_f32 v72, v72, v72
    v_and_b32 v72, 0xffff0000, v72
    v_add_f32 v72, v72, v113
    v_mov_b32 v73, v72
    s_nop 1
    v_permlane32_swap_b32 v72, v73
    s_nop 0
    v_cvt_pk_bf16_f32 v72, v72, v73
    v_mov_b32 v73, v72
    s_nop 1
    v_permlane16_swap_b32 v72, v73
    s_nop 0
    buffer_store_dwordx2 v[72:73], v116, s[44:47], 0 offen sc1
L_send:
    s_endpgm
.p2align 8
L_helper:
    v_and_b32 v0, 63, v0
    s_lshr_b32 s3, s3, 6
    s_and_b32 s4, s3, 3
    s_bfe_u32 s35, s2, 65536
    s_bfe_u32 s5, s2, 65539
    s_lshl_b32 s5, s5, 1
    s_or_b32 s35, s35, s5
    s_bfe_u32 s5, s2, 131073
    s_lshl_b32 s5, s5, 2
    s_or_b32 s35, s35, s5
    s_bfe_u32 s5, s2, 65540
    s_lshl_b32 s5, s5, 4
    s_or_b32 s35, s35, s5
    s_and_b32 s5, s2, 0xe0
    s_or_b32 s5, s5, s35
    s_waitcnt lgkmcnt(0)
    s_mov_b64 s[48:49], s[32:33]
    s_lshl_b32 s58, s35, 3
    s_add_u32 s58, s58, s34
    s_mul_i32 s58, s58, 18432
    s_and_b32 s59, s2, 7
    s_mul_i32 s59, s59, 1152
    s_lshr_b32 s60, s2, 3
    s_mul_i32 s60, s60, 165888
    s_add_u32 s59, s59, s60
    s_lshl_b32 s60, s5, 20
    s_bitcmp1_b32 s4, 0
    s_cselect_b64 s[36:37], s[20:21], s[16:17]
    s_cselect_b64 s[40:41], s[12:13], s[10:11]
    s_cselect_b32 s58, s59, s58
    s_bitcmp1_b32 s4, 1
    s_cselect_b64 s[36:37], s[40:41], s[36:37]
    s_cselect_b32 s58, s60, s58
    s_add_u32 s44, s36, s58
    s_addc_u32 s45, s37, 0
    s_and_b32 s45, s45, 0xffff
    s_mov_b32 s46, 4
    s_mov_b32 s47, 0x20000
    buffer_load_dword v61, off, s[44:47], 0 nt
    s_mul_i32 s58, s34, 1152
    s_add_u32 s36, s8, s58
    s_addc_u32 s37, s9, 0
    s_and_b32 s37, s37, 0xffff
    s_mov_b32 s38, 1152
    s_mov_b32 s39, 0x20000
    s_lshl_b32 s58, s35, 8
    s_add_u32 s40, s14, s58
    s_addc_u32 s41, s15, 0
    s_and_b32 s41, s41, 0xffff
    s_mov_b32 s42, 0
    s_mov_b32 s43, 0x20000
    s_sub_u32 s42, 4718592, s58
    v_lshrrev_b32 v1, 4, v0
    v_and_b32 v2, 15, v0
    s_lshl_b32 s59, s4, 2
    v_add_u32 v3, s59, v2
    v_and_b32 v3, 15, v3
    v_and_b32 v24, 3, v3
    v_lshrrev_b32 v3, 2, v3
    v_lshl_add_u32 v3, v3, 2, v1
    v_lshl_add_u32 v3, v3, 2, v24
    v_lshlrev_b32 v3, 1, v3
    s_lshl_b32 s84, s34, 7
    buffer_load_ushort v32, v3, s[36:39], s84 offen
    s_add_u32 s85, s84, 128
    s_cmp_eq_u32 s85, 1152
    s_cselect_b32 s85, 0, s85
    buffer_load_ushort v33, v3, s[36:39], s85 offen
    s_add_u32 s86, s85, 128
    s_cmp_eq_u32 s86, 1152
    s_cselect_b32 s86, 0, s86
    buffer_load_ushort v34, v3, s[36:39], s86 offen
    s_add_u32 s87, s86, 128
    s_cmp_eq_u32 s87, 1152
    s_cselect_b32 s87, 0, s87
    buffer_load_ushort v35, v3, s[36:39], s87 offen
    s_add_u32 s88, s87, 128
    s_cmp_eq_u32 s88, 1152
    s_cselect_b32 s88, 0, s88
    buffer_load_ushort v36, v3, s[36:39], s88 offen
    s_add_u32 s89, s88, 128
    s_cmp_eq_u32 s89, 1152
    s_cselect_b32 s89, 0, s89
    buffer_load_ushort v37, v3, s[36:39], s89 offen
    s_add_u32 s90, s89, 128
    s_cmp_eq_u32 s90, 1152
    s_cselect_b32 s90, 0, s90
    buffer_load_ushort v38, v3, s[36:39], s90 offen
    s_add_u32 s91, s90, 128
    s_cmp_eq_u32 s91, 1152
    s_cselect_b32 s91, 0, s91
    buffer_load_ushort v39, v3, s[36:39], s91 offen
    s_add_u32 s92, s91, 128
    s_cmp_eq_u32 s92, 1152
    s_cselect_b32 s92, 0, s92
    buffer_load_ushort v40, v3, s[36:39], s92 offen
    v_lshlrev_b32 v4, 15, v1
    v_lshl_add_u32 v4, v2, 4, v4
    s_lshl_b32 s59, s4, 17
    v_add_u32 v4, s59, v4
L_helper2:
    v_and_b32 v24, 1, v0
    v_lshlrev_b32 v24, 4, v24
    v_mov_b32 v25, 0xffff
    v_lshlrev_b32 v24, v24, v25
    v_bfe_u32 v25, v0, 1, 2
    v_cmp_eq_u32 vcc, 0, v25
    s_nop 1
    v_cndmask_b32 v8, 0, v24, vcc
    v_cmp_eq_u32 vcc, 1, v25
    s_nop 1
    v_cndmask_b32 v9, 0, v24, vcc
    v_cmp_eq_u32 vcc, 2, v25
    s_nop 1
    v_cndmask_b32 v10, 0, v24, vcc
    v_cmp_eq_u32 vcc, 3, v25
    s_nop 1
    v_cndmask_b32 v11, 0, v24, vcc
    s_mov_b32 s66, 0x05040100
    s_mov_b32 s67, 0x07060302
    s_mov_b32 s70, 0
    s_mov_b32 s71, -1
    s_waitcnt vmcnt(0)
    v_lshlrev_b32 v32, 16, v32
    v_lshlrev_b32 v33, 16, v33
    v_lshlrev_b32 v34, 16, v34
    v_lshlrev_b32 v35, 16, v35
    v_lshlrev_b32 v36, 16, v36
    v_lshlrev_b32 v37, 16, v37
    v_lshlrev_b32 v38, 16, v38
    v_lshlrev_b32 v39, 16, v39
    v_lshlrev_b32 v40, 16, v40
    v_add_f32 v26, v32, v33
    v_add_f32 v26, v26, v34
    v_add_f32 v26, v26, v35
    v_add_f32 v26, v26, v36
    v_add_f32 v26, v26, v37
    v_add_f32 v26, v26, v38
    v_add_f32 v26, v26, v39
    v_add_f32 v26, v26, v40
    s_nop 1
    v_add_f32_dpp v26, v26, v26 quad_perm:[1,0,3,2] row_mask:0xf bank_mask:0xf
    s_nop 1
    v_add_f32_dpp v26, v26, v26 quad_perm:[2,3,0,1] row_mask:0xf bank_mask:0xf
    s_nop 1
    v_add_f32_dpp v26, v26, v26 row_half_mirror row_mask:0xf bank_mask:0xf
    s_nop 1
    v_add_f32_dpp v26, v26, v26 row_mirror row_mask:0xf bank_mask:0xf
    v_mov_b32 v24, v26
    s_nop 1
    v_permlane16_swap_b32 v24, v26
    s_nop 1
    v_add_f32 v26, v26, v24
    v_mov_b32 v24, v26
    s_nop 1
    v_permlane32_swap_b32 v24, v26
    s_nop 1
    v_add_f32 v26, v26, v24
    v_mul_f32 v26, 0x3ae38e39, v26
    v_sub_f32 v44, v32, v26
    v_sub_f32 v45, v33, v26
    v_sub_f32 v46, v34, v26
    v_sub_f32 v47, v35, v26
    v_sub_f32 v48, v36, v26
    v_sub_f32 v49, v37, v26
    v_sub_f32 v50, v38, v26
    v_sub_f32 v51, v39, v26
    v_sub_f32 v52, v40, v26
    v_mul_f32 v27, v44, v44
    v_fmac_f32 v27, v45, v45
    v_fmac_f32 v27, v46, v46
    v_fmac_f32 v27, v47, v47
    v_fmac_f32 v27, v48, v48
    v_fmac_f32 v27, v49, v49
    v_fmac_f32 v27, v50, v50
    v_fmac_f32 v27, v51, v51
    v_fmac_f32 v27, v52, v52
    s_nop 1
    v_add_f32_dpp v27, v27, v27 quad_perm:[1,0,3,2] row_mask:0xf bank_mask:0xf
    s_nop 1
    v_add_f32_dpp v27, v27, v27 quad_perm:[2,3,0,1] row_mask:0xf bank_mask:0xf
    s_nop 1
    v_add_f32_dpp v27, v27, v27 row_half_mirror row_mask:0xf bank_mask:0xf
    s_nop 1
    v_add_f32_dpp v27, v27, v27 row_mirror row_mask:0xf bank_mask:0xf
    v_mov_b32 v24, v27
    s_nop 1
    v_permlane16_swap_b32 v24, v27
    s_nop 1
    v_add_f32 v27, v27, v24
    v_mov_b32 v24, v27
    s_nop 1
    v_permlane32_swap_b32 v24, v27
    s_nop 1
    v_add_f32 v27, v27, v24
    v_mul_f32 v27, 0x3ae38e39, v27
    v_cvt_pk_bf16_f32 v26, v26, v26
    v_and_b32 v26, 0xffff0000, v26
    v_cvt_pk_bf16_f32 v27, v27, v27
    v_and_b32 v27, 0xffff0000, v27
    v_add_f32 v27, 0x3727c5ac, v27
    v_cvt_pk_bf16_f32 v27, v27, v27
    v_and_b32 v27, 0xffff0000, v27
    v_sqrt_f32 v27, v27
    s_nop 0
    v_cvt_pk_bf16_f32 v27, v27, v27
    v_and_b32 v27, 0xffff0000, v27
    v_rcp_f32 v24, v27
    s_nop 0
    v_sub_f32 v44, v32, v26
    v_sub_f32 v45, v33, v26
    v_sub_f32 v46, v34, v26
    v_sub_f32 v47, v35, v26
    v_sub_f32 v48, v36, v26
    v_sub_f32 v49, v37, v26
    v_sub_f32 v50, v38, v26
    v_sub_f32 v51, v39, v26
    v_sub_f32 v52, v40, v26
    v_cvt_pk_bf16_f32 v44, v44, v44
    v_cvt_pk_bf16_f32 v45, v45, v45
    v_cvt_pk_bf16_f32 v46, v46, v46
    v_cvt_pk_bf16_f32 v47, v47, v47
    v_cvt_pk_bf16_f32 v48, v48, v48
    v_cvt_pk_bf16_f32 v49, v49, v49
    v_cvt_pk_bf16_f32 v50, v50, v50
    v_cvt_pk_bf16_f32 v51, v51, v51
    v_cvt_pk_bf16_f32 v52, v52, v52
    v_and_b32 v44, 0xffff0000, v44
    v_and_b32 v45, 0xffff0000, v45
    v_and_b32 v46, 0xffff0000, v46
    v_and_b32 v47, 0xffff0000, v47
    v_and_b32 v48, 0xffff0000, v48
    v_and_b32 v49, 0xffff0000, v49
    v_and_b32 v50, 0xffff0000, v50
    v_and_b32 v51, 0xffff0000, v51
    v_and_b32 v52, 0xffff0000, v52
    v_mul_f32 v32, v44, v24
    v_fma_f32 v25, -v32, v27, v44
    v_fmac_f32 v32, v25, v24
    v_mul_f32 v33, v45, v24
    v_fma_f32 v25, -v33, v27, v45
    v_fmac_f32 v33, v25, v24
    v_mul_f32 v34, v46, v24
    v_fma_f32 v25, -v34, v27, v46
    v_fmac_f32 v34, v25, v24
    v_mul_f32 v35, v47, v24
    v_fma_f32 v25, -v35, v27, v47
    v_fmac_f32 v35, v25, v24
    v_mul_f32 v36, v48, v24
    v_fma_f32 v25, -v36, v27, v48
    v_fmac_f32 v36, v25, v24
    v_mul_f32 v37, v49, v24
    v_fma_f32 v25, -v37, v27, v49
    v_fmac_f32 v37, v25, v24
    v_mul_f32 v38, v50, v24
    v_fma_f32 v25, -v38, v27, v50
    v_fmac_f32 v38, v25, v24
    v_mul_f32 v39, v51, v24
    v_fma_f32 v25, -v39, v27, v51
    v_fmac_f32 v39, v25, v24
    v_mul_f32 v40, v52, v24
    v_fma_f32 v25, -v40, v27, v52
    v_fmac_f32 v40, v25, v24
    v_cvt_pk_bf16_f32 v32, v32, v32
    v_cvt_pk_bf16_f32 v33, v33, v33
    v_cvt_pk_bf16_f32 v34, v34, v34
    v_cvt_pk_bf16_f32 v35, v35, v35
    v_cvt_pk_bf16_f32 v36, v36, v36
    v_cvt_pk_bf16_f32 v37, v37, v37
    v_cvt_pk_bf16_f32 v38, v38, v38
    v_cvt_pk_bf16_f32 v39, v39, v39
    v_cvt_pk_bf16_f32 v40, v40, v40
    v_mov_b32 v20, 0
    v_mov_b32 v21, 0
    v_mov_b32 v22, 0
    v_mov_b32 v23, 0
    s_lshl_b32 s56, s84, 12
    buffer_load_dwordx4 v[64:67], v4, s[40:43], s56 offen
    s_add_u32 s56, s56, 8192
    buffer_load_dwordx4 v[68:71], v4, s[40:43], s56 offen
    s_add_u32 s56, s56, 8192
    buffer_load_dwordx4 v[72:75], v4, s[40:43], s56 offen
    v_and_b32_dpp v12, v32, v8 row_newbcast:0 row_mask:0xf bank_mask:0xf
    v_and_b32_dpp v13, v32, v9 row_newbcast:0 row_mask:0xf bank_mask:0xf
    v_and_b32_dpp v14, v32, v10 row_newbcast:0 row_mask:0xf bank_mask:0xf
    v_and_b32_dpp v15, v32, v11 row_newbcast:0 row_mask:0xf bank_mask:0xf
    v_and_b32_dpp v16, v32, v8 row_newbcast:1 row_mask:0xf bank_mask:0xf
    v_and_b32_dpp v17, v32, v9 row_newbcast:1 row_mask:0xf bank_mask:0xf
    v_and_b32_dpp v18, v32, v10 row_newbcast:1 row_mask:0xf bank_mask:0xf
    v_and_b32_dpp v19, v32, v11 row_newbcast:1 row_mask:0xf bank_mask:0xf
    s_waitcnt vmcnt(2)
    v_mfma_f32_16x16x32_bf16 v[20:23], v[12:15], v[64:67], v[20:23]
    s_add_u32 s56, s56, 8192
    buffer_load_dwordx4 v[76:79], v4, s[40:43], s56 offen
    v_and_b32_dpp v12, v32, v8 row_newbcast:2 row_mask:0xf bank_mask:0xf
    v_and_b32_dpp v13, v32, v9 row_newbcast:2 row_mask:0xf bank_mask:0xf
    v_and_b32_dpp v14, v32, v10 row_newbcast:2 row_mask:0xf bank_mask:0xf
    v_and_b32_dpp v15, v32, v11 row_newbcast:2 row_mask:0xf bank_mask:0xf
    s_waitcnt vmcnt(2)
    v_mfma_f32_16x16x32_bf16 v[20:23], v[16:19], v[68:71], v[20:23]
    s_lshl_b32 s56, s85, 12
    buffer_load_dwordx4 v[80:83], v4, s[40:43], s56 offen
    v_and_b32_dpp v16, v32, v8 row_newbcast:3 row_mask:0xf bank_mask:0xf
    v_and_b32_dpp v17, v32, v9 row_newbcast:3 row_mask:0xf bank_mask:0xf
    v_and_b32_dpp v18, v32, v10 row_newbcast:3 row_mask:0xf bank_mask:0xf
    v_and_b32_dpp v19, v32, v11 row_newbcast:3 row_mask:0xf bank_mask:0xf
    s_waitcnt vmcnt(2)
    v_mfma_f32_16x16x32_bf16 v[20:23], v[12:15], v[72:75], v[20:23]
    s_add_u32 s56, s56, 8192
    buffer_load_dwordx4 v[84:87], v4, s[40:43], s56 offen
    v_and_b32_dpp v12, v33, v8 row_newbcast:0 row_mask:0xf bank_mask:0xf
    v_and_b32_dpp v13, v33, v9 row_newbcast:0 row_mask:0xf bank_mask:0xf
    v_and_b32_dpp v14, v33, v10 row_newbcast:0 row_mask:0xf bank_mask:0xf
    v_and_b32_dpp v15, v33, v11 row_newbcast:0 row_mask:0xf bank_mask:0xf
    s_waitcnt vmcnt(2)
    v_mfma_f32_16x16x32_bf16 v[20:23], v[16:19], v[76:79], v[20:23]
    s_add_u32 s56, s56, 8192
    buffer_load_dwordx4 v[88:91], v4, s[40:43], s56 offen
    v_and_b32_dpp v16, v33, v8 row_newbcast:1 row_mask:0xf bank_mask:0xf
    v_and_b32_dpp v17, v33, v9 row_newbcast:1 row_mask:0xf bank_mask:0xf
    v_and_b32_dpp v18, v33, v10 row_newbcast:1 row_mask:0xf bank_mask:0xf
    v_and_b32_dpp v19, v33, v11 row_newbcast:1 row_mask:0xf bank_mask:0xf
    s_waitcnt vmcnt(2)
    v_mfma_f32_16x16x32_bf16 v[20:23], v[12:15], v[80:83], v[20:23]
    s_add_u32 s56, s56, 8192
    buffer_load_dwordx4 v[92:95], v4, s[40:43], s56 offen
    v_and_b32_dpp v12, v33, v8 row_newbcast:2 row_mask:0xf bank_mask:0xf
    v_and_b32_dpp v13, v33, v9 row_newbcast:2 row_mask:0xf bank_mask:0xf
    v_and_b32_dpp v14, v33, v10 row_newbcast:2 row_mask:0xf bank_mask:0xf
    v_and_b32_dpp v15, v33, v11 row_newbcast:2 row_mask:0xf bank_mask:0xf
    s_waitcnt vmcnt(2)
    v_mfma_f32_16x16x32_bf16 v[20:23], v[16:19], v[84:87], v[20:23]
    s_lshl_b32 s56, s86, 12
    buffer_load_dwordx4 v[96:99], v4, s[40:43], s56 offen
    v_and_b32_dpp v16, v33, v8 row_newbcast:3 row_mask:0xf bank_mask:0xf
    v_and_b32_dpp v17, v33, v9 row_newbcast:3 row_mask:0xf bank_mask:0xf
    v_and_b32_dpp v18, v33, v10 row_newbcast:3 row_mask:0xf bank_mask:0xf
    v_and_b32_dpp v19, v33, v11 row_newbcast:3 row_mask:0xf bank_mask:0xf
    s_waitcnt vmcnt(2)
    v_mfma_f32_16x16x32_bf16 v[20:23], v[12:15], v[88:91], v[20:23]
    s_add_u32 s56, s56, 8192
    buffer_load_dwordx4 v[100:103], v4, s[40:43], s56 offen
    v_and_b32_dpp v12, v34, v8 row_newbcast:0 row_mask:0xf bank_mask:0xf
    v_and_b32_dpp v13, v34, v9 row_newbcast:0 row_mask:0xf bank_mask:0xf
    v_and_b32_dpp v14, v34, v10 row_newbcast:0 row_mask:0xf bank_mask:0xf
    v_and_b32_dpp v15, v34, v11 row_newbcast:0 row_mask:0xf bank_mask:0xf
    s_waitcnt vmcnt(2)
    v_mfma_f32_16x16x32_bf16 v[20:23], v[16:19], v[92:95], v[20:23]
    s_add_u32 s56, s56, 8192
    buffer_load_dwordx4 v[104:107], v4, s[40:43], s56 offen
    v_and_b32_dpp v16, v34, v8 row_newbcast:1 row_mask:0xf bank_mask:0xf
    v_and_b32_dpp v17, v34, v9 row_newbcast:1 row_mask:0xf bank_mask:0xf
    v_and_b32_dpp v18, v34, v10 row_newbcast:1 row_mask:0xf bank_mask:0xf
    v_and_b32_dpp v19, v34, v11 row_newbcast:1 row_mask:0xf bank_mask:0xf
    s_waitcnt vmcnt(2)
    v_mfma_f32_16x16x32_bf16 v[20:23], v[12:15], v[96:99], v[20:23]
    s_add_u32 s56, s56, 8192
    buffer_load_dwordx4 v[108:111], v4, s[40:43], s56 offen
    v_and_b32_dpp v12, v34, v8 row_newbcast:2 row_mask:0xf bank_mask:0xf
    v_and_b32_dpp v13, v34, v9 row_newbcast:2 row_mask:0xf bank_mask:0xf
    v_and_b32_dpp v14, v34, v10 row_newbcast:2 row_mask:0xf bank_mask:0xf
    v_and_b32_dpp v15, v34, v11 row_newbcast:2 row_mask:0xf bank_mask:0xf
    s_waitcnt vmcnt(2)
    v_mfma_f32_16x16x32_bf16 v[20:23], v[16:19], v[100:103], v[20:23]
    s_lshl_b32 s56, s87, 12
    buffer_load_dwordx4 v[112:115], v4, s[40:43], s56 offen
    v_and_b32_dpp v16, v34, v8 row_newbcast:3 row_mask:0xf bank_mask:0xf
    v_and_b32_dpp v17, v34, v9 row_newbcast:3 row_mask:0xf bank_mask:0xf
    v_and_b32_dpp v18, v34, v10 row_newbcast:3 row_mask:0xf bank_mask:0xf
    v_and_b32_dpp v19, v34, v11 row_newbcast:3 row_mask:0xf bank_mask:0xf
    s_waitcnt vmcnt(2)
    v_mfma_f32_16x16x32_bf16 v[20:23], v[12:15], v[104:107], v[20:23]
    s_add_u32 s56, s56, 8192
    buffer_load_dwordx4 v[116:119], v4, s[40:43], s56 offen
    v_and_b32_dpp v12, v35, v8 row_newbcast:0 row_mask:0xf bank_mask:0xf
    v_and_b32_dpp v13, v35, v9 row_newbcast:0 row_mask:0xf bank_mask:0xf
    v_and_b32_dpp v14, v35, v10 row_newbcast:0 row_mask:0xf bank_mask:0xf
    v_and_b32_dpp v15, v35, v11 row_newbcast:0 row_mask:0xf bank_mask:0xf
    s_waitcnt vmcnt(2)
    v_mfma_f32_16x16x32_bf16 v[20:23], v[16:19], v[108:111], v[20:23]
    s_add_u32 s56, s56, 8192
    buffer_load_dwordx4 v[120:123], v4, s[40:43], s56 offen
    v_and_b32_dpp v16, v35, v8 row_newbcast:1 row_mask:0xf bank_mask:0xf
    v_and_b32_dpp v17, v35, v9 row_newbcast:1 row_mask:0xf bank_mask:0xf
    v_and_b32_dpp v18, v35, v10 row_newbcast:1 row_mask:0xf bank_mask:0xf
    v_and_b32_dpp v19, v35, v11 row_newbcast:1 row_mask:0xf bank_mask:0xf
    s_waitcnt vmcnt(2)
    v_mfma_f32_16x16x32_bf16 v[20:23], v[12:15], v[112:115], v[20:23]
    s_add_u32 s56, s56, 8192
    buffer_load_dwordx4 v[124:127], v4, s[40:43], s56 offen
    v_and_b32_dpp v12, v35, v8 row_newbcast:2 row_mask:0xf bank_mask:0xf
    v_and_b32_dpp v13, v35, v9 row_newbcast:2 row_mask:0xf bank_mask:0xf
    v_and_b32_dpp v14, v35, v10 row_newbcast:2 row_mask:0xf bank_mask:0xf
    v_and_b32_dpp v15, v35, v11 row_newbcast:2 row_mask:0xf bank_mask:0xf
    s_waitcnt vmcnt(2)
    v_mfma_f32_16x16x32_bf16 v[20:23], v[16:19], v[116:119], v[20:23]
    s_lshl_b32 s56, s88, 12
    buffer_load_dwordx4 v[128:131], v4, s[40:43], s56 offen
    v_and_b32_dpp v16, v35, v8 row_newbcast:3 row_mask:0xf bank_mask:0xf
    v_and_b32_dpp v17, v35, v9 row_newbcast:3 row_mask:0xf bank_mask:0xf
    v_and_b32_dpp v18, v35, v10 row_newbcast:3 row_mask:0xf bank_mask:0xf
    v_and_b32_dpp v19, v35, v11 row_newbcast:3 row_mask:0xf bank_mask:0xf
    s_waitcnt vmcnt(2)
    v_mfma_f32_16x16x32_bf16 v[20:23], v[12:15], v[120:123], v[20:23]
    s_add_u32 s56, s56, 8192
    buffer_load_dwordx4 v[132:135], v4, s[40:43], s56 offen
    v_and_b32_dpp v12, v36, v8 row_newbcast:0 row_mask:0xf bank_mask:0xf
    v_and_b32_dpp v13, v36, v9 row_newbcast:0 row_mask:0xf bank_mask:0xf
    v_and_b32_dpp v14, v36, v10 row_newbcast:0 row_mask:0xf bank_mask:0xf
    v_and_b32_dpp v15, v36, v11 row_newbcast:0 row_mask:0xf bank_mask:0xf
    s_waitcnt vmcnt(2)
    v_mfma_f32_16x16x32_bf16 v[20:23], v[16:19], v[124:127], v[20:23]
    s_add_u32 s56, s56, 8192
    buffer_load_dwordx4 v[136:139], v4, s[40:43], s56 offen
    v_and_b32_dpp v16, v36, v8 row_newbcast:1 row_mask:0xf bank_mask:0xf
    v_and_b32_dpp v17, v36, v9 row_newbcast:1 row_mask:0xf bank_mask:0xf
    v_and_b32_dpp v18, v36, v10 row_newbcast:1 row_mask:0xf bank_mask:0xf
    v_and_b32_dpp v19, v36, v11 row_newbcast:1 row_mask:0xf bank_mask:0xf
    s_waitcnt vmcnt(2)
    v_mfma_f32_16x16x32_bf16 v[20:23], v[12:15], v[128:131], v[20:23]
    s_add_u32 s56, s56, 8192
    buffer_load_dwordx4 v[140:143], v4, s[40:43], s56 offen
    v_and_b32_dpp v12, v36, v8 row_newbcast:2 row_mask:0xf bank_mask:0xf
    v_and_b32_dpp v13, v36, v9 row_newbcast:2 row_mask:0xf bank_mask:0xf
    v_and_b32_dpp v14, v36, v10 row_newbcast:2 row_mask:0xf bank_mask:0xf
    v_and_b32_dpp v15, v36, v11 row_newbcast:2 row_mask:0xf bank_mask:0xf
    s_waitcnt vmcnt(2)
    v_mfma_f32_16x16x32_bf16 v[20:23], v[16:19], v[132:135], v[20:23]
    s_lshl_b32 s56, s89, 12
    buffer_load_dwordx4 v[144:147], v4, s[40:43], s56 offen
    v_and_b32_dpp v16, v36, v8 row_newbcast:3 row_mask:0xf bank_mask:0xf
    v_and_b32_dpp v17, v36, v9 row_newbcast:3 row_mask:0xf bank_mask:0xf
    v_and_b32_dpp v18, v36, v10 row_newbcast:3 row_mask:0xf bank_mask:0xf
    v_and_b32_dpp v19, v36, v11 row_newbcast:3 row_mask:0xf bank_mask:0xf
    s_waitcnt vmcnt(2)
    v_mfma_f32_16x16x32_bf16 v[20:23], v[12:15], v[136:139], v[20:23]
    s_add_u32 s56, s56, 8192
    buffer_load_dwordx4 v[148:151], v4, s[40:43], s56 offen
    v_and_b32_dpp v12, v37, v8 row_newbcast:0 row_mask:0xf bank_mask:0xf
    v_and_b32_dpp v13, v37, v9 row_newbcast:0 row_mask:0xf bank_mask:0xf
    v_and_b32_dpp v14, v37, v10 row_newbcast:0 row_mask:0xf bank_mask:0xf
    v_and_b32_dpp v15, v37, v11 row_newbcast:0 row_mask:0xf bank_mask:0xf
    s_waitcnt vmcnt(2)
    v_mfma_f32_16x16x32_bf16 v[20:23], v[16:19], v[140:143], v[20:23]
    s_add_u32 s56, s56, 8192
    buffer_load_dwordx4 v[152:155], v4, s[40:43], s56 offen
    v_and_b32_dpp v16, v37, v8 row_newbcast:1 row_mask:0xf bank_mask:0xf
    v_and_b32_dpp v17, v37, v9 row_newbcast:1 row_mask:0xf bank_mask:0xf
    v_and_b32_dpp v18, v37, v10 row_newbcast:1 row_mask:0xf bank_mask:0xf
    v_and_b32_dpp v19, v37, v11 row_newbcast:1 row_mask:0xf bank_mask:0xf
    s_waitcnt vmcnt(2)
    v_mfma_f32_16x16x32_bf16 v[20:23], v[12:15], v[144:147], v[20:23]
    s_add_u32 s56, s56, 8192
    buffer_load_dwordx4 v[156:159], v4, s[40:43], s56 offen
    v_and_b32_dpp v12, v37, v8 row_newbcast:2 row_mask:0xf bank_mask:0xf
    v_and_b32_dpp v13, v37, v9 row_newbcast:2 row_mask:0xf bank_mask:0xf
    v_and_b32_dpp v14, v37, v10 row_newbcast:2 row_mask:0xf bank_mask:0xf
    v_and_b32_dpp v15, v37, v11 row_newbcast:2 row_mask:0xf bank_mask:0xf
    s_waitcnt vmcnt(2)
    v_mfma_f32_16x16x32_bf16 v[20:23], v[16:19], v[148:151], v[20:23]
    s_lshl_b32 s56, s90, 12
    buffer_load_dwordx4 v[160:163], v4, s[40:43], s56 offen
    v_and_b32_dpp v16, v37, v8 row_newbcast:3 row_mask:0xf bank_mask:0xf
    v_and_b32_dpp v17, v37, v9 row_newbcast:3 row_mask:0xf bank_mask:0xf
    v_and_b32_dpp v18, v37, v10 row_newbcast:3 row_mask:0xf bank_mask:0xf
    v_and_b32_dpp v19, v37, v11 row_newbcast:3 row_mask:0xf bank_mask:0xf
    s_waitcnt vmcnt(2)
    v_mfma_f32_16x16x32_bf16 v[20:23], v[12:15], v[152:155], v[20:23]
    s_add_u32 s56, s56, 8192
    buffer_load_dwordx4 v[164:167], v4, s[40:43], s56 offen
    v_and_b32_dpp v12, v38, v8 row_newbcast:0 row_mask:0xf bank_mask:0xf
    v_and_b32_dpp v13, v38, v9 row_newbcast:0 row_mask:0xf bank_mask:0xf
    v_and_b32_dpp v14, v38, v10 row_newbcast:0 row_mask:0xf bank_mask:0xf
    v_and_b32_dpp v15, v38, v11 row_newbcast:0 row_mask:0xf bank_mask:0xf
    s_waitcnt vmcnt(2)
    v_mfma_f32_16x16x32_bf16 v[20:23], v[16:19], v[156:159], v[20:23]
    s_add_u32 s56, s56, 8192
    buffer_load_dwordx4 v[168:171], v4, s[40:43], s56 offen
    v_and_b32_dpp v16, v38, v8 row_newbcast:1 row_mask:0xf bank_mask:0xf
    v_and_b32_dpp v17, v38, v9 row_newbcast:1 row_mask:0xf bank_mask:0xf
    v_and_b32_dpp v18, v38, v10 row_newbcast:1 row_mask:0xf bank_mask:0xf
    v_and_b32_dpp v19, v38, v11 row_newbcast:1 row_mask:0xf bank_mask:0xf
    s_waitcnt vmcnt(2)
    v_mfma_f32_16x16x32_bf16 v[20:23], v[12:15], v[160:163], v[20:23]
    s_add_u32 s56, s56, 8192
    buffer_load_dwordx4 v[172:175], v4, s[40:43], s56 offen
    v_and_b32_dpp v12, v38, v8 row_newbcast:2 row_mask:0xf bank_mask:0xf
    v_and_b32_dpp v13, v38, v9 row_newbcast:2 row_mask:0xf bank_mask:0xf
    v_and_b32_dpp v14, v38, v10 row_newbcast:2 row_mask:0xf bank_mask:0xf
    v_and_b32_dpp v15, v38, v11 row_newbcast:2 row_mask:0xf bank_mask:0xf
    s_waitcnt vmcnt(2)
    v_mfma_f32_16x16x32_bf16 v[20:23], v[16:19], v[164:167], v[20:23]
    s_lshl_b32 s56, s91, 12
    buffer_load_dwordx4 v[176:179], v4, s[40:43], s56 offen
    v_and_b32_dpp v16, v38, v8 row_newbcast:3 row_mask:0xf bank_mask:0xf
    v_and_b32_dpp v17, v38, v9 row_newbcast:3 row_mask:0xf bank_mask:0xf
    v_and_b32_dpp v18, v38, v10 row_newbcast:3 row_mask:0xf bank_mask:0xf
    v_and_b32_dpp v19, v38, v11 row_newbcast:3 row_mask:0xf bank_mask:0xf
    s_waitcnt vmcnt(2)
    v_mfma_f32_16x16x32_bf16 v[20:23], v[12:15], v[168:171], v[20:23]
    s_add_u32 s56, s56, 8192
    buffer_load_dwordx4 v[180:183], v4, s[40:43], s56 offen
    v_and_b32_dpp v12, v39, v8 row_newbcast:0 row_mask:0xf bank_mask:0xf
    v_and_b32_dpp v13, v39, v9 row_newbcast:0 row_mask:0xf bank_mask:0xf
    v_and_b32_dpp v14, v39, v10 row_newbcast:0 row_mask:0xf bank_mask:0xf
    v_and_b32_dpp v15, v39, v11 row_newbcast:0 row_mask:0xf bank_mask:0xf
    s_waitcnt vmcnt(2)
    v_mfma_f32_16x16x32_bf16 v[20:23], v[16:19], v[172:175], v[20:23]
    s_add_u32 s56, s56, 8192
    buffer_load_dwordx4 v[184:187], v4, s[40:43], s56 offen
    v_and_b32_dpp v16, v39, v8 row_newbcast:1 row_mask:0xf bank_mask:0xf
    v_and_b32_dpp v17, v39, v9 row_newbcast:1 row_mask:0xf bank_mask:0xf
    v_and_b32_dpp v18, v39, v10 row_newbcast:1 row_mask:0xf bank_mask:0xf
    v_and_b32_dpp v19, v39, v11 row_newbcast:1 row_mask:0xf bank_mask:0xf
    s_waitcnt vmcnt(2)
    v_mfma_f32_16x16x32_bf16 v[20:23], v[12:15], v[176:179], v[20:23]
    s_add_u32 s56, s56, 8192
    buffer_load_dwordx4 v[188:191], v4, s[40:43], s56 offen
    v_and_b32_dpp v12, v39, v8 row_newbcast:2 row_mask:0xf bank_mask:0xf
    v_and_b32_dpp v13, v39, v9 row_newbcast:2 row_mask:0xf bank_mask:0xf
    v_and_b32_dpp v14, v39, v10 row_newbcast:2 row_mask:0xf bank_mask:0xf
    v_and_b32_dpp v15, v39, v11 row_newbcast:2 row_mask:0xf bank_mask:0xf
    s_waitcnt vmcnt(2)
    v_mfma_f32_16x16x32_bf16 v[20:23], v[16:19], v[180:183], v[20:23]
    s_lshl_b32 s56, s92, 12
    buffer_load_dwordx4 v[192:195], v4, s[40:43], s56 offen
    v_and_b32_dpp v16, v39, v8 row_newbcast:3 row_mask:0xf bank_mask:0xf
    v_and_b32_dpp v17, v39, v9 row_newbcast:3 row_mask:0xf bank_mask:0xf
    v_and_b32_dpp v18, v39, v10 row_newbcast:3 row_mask:0xf bank_mask:0xf
    v_and_b32_dpp v19, v39, v11 row_newbcast:3 row_mask:0xf bank_mask:0xf
    s_waitcnt vmcnt(2)
    v_mfma_f32_16x16x32_bf16 v[20:23], v[12:15], v[184:187], v[20:23]
    s_add_u32 s56, s56, 8192
    buffer_load_dwordx4 v[196:199], v4, s[40:43], s56 offen
    v_and_b32_dpp v12, v40, v8 row_newbcast:0 row_mask:0xf bank_mask:0xf
    v_and_b32_dpp v13, v40, v9 row_newbcast:0 row_mask:0xf bank_mask:0xf
    v_and_b32_dpp v14, v40, v10 row_newbcast:0 row_mask:0xf bank_mask:0xf
    v_and_b32_dpp v15, v40, v11 row_newbcast:0 row_mask:0xf bank_mask:0xf
    s_waitcnt vmcnt(2)
    v_mfma_f32_16x16x32_bf16 v[20:23], v[16:19], v[188:191], v[20:23]
    s_add_u32 s56, s56, 8192
    buffer_load_dwordx4 v[200:203], v4, s[40:43], s56 offen
    v_and_b32_dpp v16, v40, v8 row_newbcast:1 row_mask:0xf bank_mask:0xf
    v_and_b32_dpp v17, v40, v9 row_newbcast:1 row_mask:0xf bank_mask:0xf
    v_and_b32_dpp v18, v40, v10 row_newbcast:1 row_mask:0xf bank_mask:0xf
    v_and_b32_dpp v19, v40, v11 row_newbcast:1 row_mask:0xf bank_mask:0xf
    s_waitcnt vmcnt(2)
    v_mfma_f32_16x16x32_bf16 v[20:23], v[12:15], v[192:195], v[20:23]
    s_add_u32 s56, s56, 8192
    buffer_load_dwordx4 v[204:207], v4, s[40:43], s56 offen
    v_and_b32_dpp v12, v40, v8 row_newbcast:2 row_mask:0xf bank_mask:0xf
    v_and_b32_dpp v13, v40, v9 row_newbcast:2 row_mask:0xf bank_mask:0xf
    v_and_b32_dpp v14, v40, v10 row_newbcast:2 row_mask:0xf bank_mask:0xf
    v_and_b32_dpp v15, v40, v11 row_newbcast:2 row_mask:0xf bank_mask:0xf
    s_waitcnt vmcnt(2)
    v_mfma_f32_16x16x32_bf16 v[20:23], v[16:19], v[196:199], v[20:23]
    v_and_b32_dpp v16, v40, v8 row_newbcast:3 row_mask:0xf bank_mask:0xf
    v_and_b32_dpp v17, v40, v9 row_newbcast:3 row_mask:0xf bank_mask:0xf
    v_and_b32_dpp v18, v40, v10 row_newbcast:3 row_mask:0xf bank_mask:0xf
    v_and_b32_dpp v19, v40, v11 row_newbcast:3 row_mask:0xf bank_mask:0xf
    s_waitcnt vmcnt(1)
    v_mfma_f32_16x16x32_bf16 v[20:23], v[12:15], v[200:203], v[20:23]
    v_and_b32 v24, 1, v1
    v_lshlrev_b32 v24, 4, v24
    v_lshl_add_u32 v24, v2, 5, v24
    s_lshl_b32 s59, s4, 9
    v_add_u32 v24, s59, v24
    s_waitcnt vmcnt(0)
    v_mfma_f32_16x16x32_bf16 v[20:23], v[16:19], v[204:207], v[20:23]
    s_nop 7
    ds_write_b128 v24, v[20:23] offset:0
    v_mov_b32 v25, 64
    ds_write_b32 v25, v25 offset:3296
    s_mov_b32 s52, 0
    v_mov_b32 v26, 0
    s_add_u32 s59, s52, 0
    v_mov_b32 v27, s59
    ds_write_b32 v25, v26 offset:3300
    ds_write_b32 v25, v27 offset:3304
    ds_write_b128 v25, v[56:59] offset:3264
    ds_write_b128 v25, v[56:59] offset:3280
    s_waitcnt lgkmcnt(0)
    s_barrier
    s_or_b32 s58, s54, s4
    s_cbranch_scc1 L_nocount
    s_mov_b32 s58, 1
    s_atomic_add s58, s[30:31], 0
    s_waitcnt lgkmcnt(0)
L_nocount:
    s_mul_i32 s58, s5, 2304
    s_lshl_b32 s59, s4, 9
    s_add_u32 s59, s59, s58
    v_and_b32 v5, 1, v1
    v_lshlrev_b32 v5, 4, v5
    v_lshl_add_u32 v5, v2, 5, v5
    v_add_u32 v5, s59, v5
    s_lshl_b32 s59, s4, 6
    s_add_u32 s59, s59, s58
    s_add_u32 s59, s59, 2048
    v_lshlrev_b32 v6, 2, v0
    v_add_u32 v6, s59, v6
    v_lshrrev_b32 v24, 1, v1
    v_lshl_add_u32 v5, v24, 24, v5
    v_lshl_add_u32 v6, v1, 24, v6
    s_cmp_lg_u32 s4, 3
    s_cbranch_scc1 L_nog1
    s_lshr_b32 s54, s2, 3
    s_sub_u32 s54, s54, 14
    s_cmp_ge_u32 s54, 9
    s_cbranch_scc1 L_nog1
    s_and_b32 s58, s2, 7
    s_mul_i32 s58, s58, 9
    s_add_u32 s54, s54, s58
    s_lshl_b32 s54, s54, 7
    s_mov_b32 s36, s8
    s_and_b32 s37, s9, 0xffff
    s_mov_b32 s38, 9216
    s_mov_b32 s39, 0x20000
    v_lshrrev_b32 v24, 3, v0
    v_and_b32 v25, 7, v0
    v_lshlrev_b32 v25, 4, v25
    v_mul_u32_u24 v3, 1152, v24
    v_add_u32 v3, v3, v25
    v_mul_u32_u24 v4, 1168, v24
    v_add_u32 v4, v4, v25
    buffer_load_dwordx4 v[64:67], v3, s[36:39], 0 offen offset:0
    buffer_load_dwordx4 v[68:71], v3, s[36:39], 0 offen offset:128
    buffer_load_dwordx4 v[72:75], v3, s[36:39], 0 offen offset:256
    buffer_load_dwordx4 v[76:79], v3, s[36:39], 0 offen offset:384
    buffer_load_dwordx4 v[80:83], v3, s[36:39], 0 offen offset:512
    buffer_load_dwordx4 v[84:87], v3, s[36:39], 0 offen offset:640
    buffer_load_dwordx4 v[88:91], v3, s[36:39], 0 offen offset:768
    buffer_load_dwordx4 v[92:95], v3, s[36:39], 0 offen offset:896
    buffer_load_dwordx4 v[96:99], v3, s[36:39], 0 offen offset:1024
    s_add_u32 s44, s22, s54
    s_addc_u32 s45, s23, 0
    s_and_b32 s45, s45, 0xffff
    s_mov_b32 s46, 128
    s_mov_b32 s47, 0x20000
    v_lshlrev_b32 v25, 3, v2
    buffer_load_dwordx2 v[8:9], v25, s[44:47], 0 offen
    v_mov_b32 v26, 0
    v_mov_b32 v27, 0
    s_waitcnt vmcnt(0)
    v_lshlrev_b32 v24, 16, v64
    v_and_b32 v25, 0xffff0000, v64
    v_add_f32 v26, v26, v24
    v_add_f32 v27, v27, v25
    v_lshlrev_b32 v24, 16, v65
    v_and_b32 v25, 0xffff0000, v65
    v_add_f32 v26, v26, v24
    v_add_f32 v27, v27, v25
    v_lshlrev_b32 v24, 16, v66
    v_and_b32 v25, 0xffff0000, v66
    v_add_f32 v26, v26, v24
    v_add_f32 v27, v27, v25
    v_lshlrev_b32 v24, 16, v67
    v_and_b32 v25, 0xffff0000, v67
    v_add_f32 v26, v26, v24
    v_add_f32 v27, v27, v25
    v_lshlrev_b32 v24, 16, v68
    v_and_b32 v25, 0xffff0000, v68
    v_add_f32 v26, v26, v24
    v_add_f32 v27, v27, v25
    v_lshlrev_b32 v24, 16, v69
    v_and_b32 v25, 0xffff0000, v69
    v_add_f32 v26, v26, v24
    v_add_f32 v27, v27, v25
    v_lshlrev_b32 v24, 16, v70
    v_and_b32 v25, 0xffff0000, v70
    v_add_f32 v26, v26, v24
    v_add_f32 v27, v27, v25
    v_lshlrev_b32 v24, 16, v71
    v_and_b32 v25, 0xffff0000, v71
    v_add_f32 v26, v26, v24
    v_add_f32 v27, v27, v25
    v_lshlrev_b32 v24, 16, v72
    v_and_b32 v25, 0xffff0000, v72
    v_add_f32 v26, v26, v24
    v_add_f32 v27, v27, v25
    v_lshlrev_b32 v24, 16, v73
    v_and_b32 v25, 0xffff0000, v73
    v_add_f32 v26, v26, v24
    v_add_f32 v27, v27, v25
    v_lshlrev_b32 v24, 16, v74
    v_and_b32 v25, 0xffff0000, v74
    v_add_f32 v26, v26, v24
    v_add_f32 v27, v27, v25
    v_lshlrev_b32 v24, 16, v75
    v_and_b32 v25, 0xffff0000, v75
    v_add_f32 v26, v26, v24
    v_add_f32 v27, v27, v25
    v_lshlrev_b32 v24, 16, v76
    v_and_b32 v25, 0xffff0000, v76
    v_add_f32 v26, v26, v24
    v_add_f32 v27, v27, v25
    v_lshlrev_b32 v24, 16, v77
    v_and_b32 v25, 0xffff0000, v77
    v_add_f32 v26, v26, v24
    v_add_f32 v27, v27, v25
    v_lshlrev_b32 v24, 16, v78
    v_and_b32 v25, 0xffff0000, v78
    v_add_f32 v26, v26, v24
    v_add_f32 v27, v27, v25
    v_lshlrev_b32 v24, 16, v79
    v_and_b32 v25, 0xffff0000, v79
    v_add_f32 v26, v26, v24
    v_add_f32 v27, v27, v25
    v_lshlrev_b32 v24, 16, v80
    v_and_b32 v25, 0xffff0000, v80
    v_add_f32 v26, v26, v24
    v_add_f32 v27, v27, v25
    v_lshlrev_b32 v24, 16, v81
    v_and_b32 v25, 0xffff0000, v81
    v_add_f32 v26, v26, v24
    v_add_f32 v27, v27, v25
    v_lshlrev_b32 v24, 16, v82
    v_and_b32 v25, 0xffff0000, v82
    v_add_f32 v26, v26, v24
    v_add_f32 v27, v27, v25
    v_lshlrev_b32 v24, 16, v83
    v_and_b32 v25, 0xffff0000, v83
    v_add_f32 v26, v26, v24
    v_add_f32 v27, v27, v25
    v_lshlrev_b32 v24, 16, v84
    v_and_b32 v25, 0xffff0000, v84
    v_add_f32 v26, v26, v24
    v_add_f32 v27, v27, v25
    v_lshlrev_b32 v24, 16, v85
    v_and_b32 v25, 0xffff0000, v85
    v_add_f32 v26, v26, v24
    v_add_f32 v27, v27, v25
    v_lshlrev_b32 v24, 16, v86
    v_and_b32 v25, 0xffff0000, v86
    v_add_f32 v26, v26, v24
    v_add_f32 v27, v27, v25
    v_lshlrev_b32 v24, 16, v87
    v_and_b32 v25, 0xffff0000, v87
    v_add_f32 v26, v26, v24
    v_add_f32 v27, v27, v25
    v_lshlrev_b32 v24, 16, v88
    v_and_b32 v25, 0xffff0000, v88
    v_add_f32 v26, v26, v24
    v_add_f32 v27, v27, v25
    v_lshlrev_b32 v24, 16, v89
    v_and_b32 v25, 0xffff0000, v89
    v_add_f32 v26, v26, v24
    v_add_f32 v27, v27, v25
    v_lshlrev_b32 v24, 16, v90
    v_and_b32 v25, 0xffff0000, v90
    v_add_f32 v26, v26, v24
    v_add_f32 v27, v27, v25
    v_lshlrev_b32 v24, 16, v91
    v_and_b32 v25, 0xffff0000, v91
    v_add_f32 v26, v26, v24
    v_add_f32 v27, v27, v25
    v_lshlrev_b32 v24, 16, v92
    v_and_b32 v25, 0xffff0000, v92
    v_add_f32 v26, v26, v24
    v_add_f32 v27, v27, v25
    v_lshlrev_b32 v24, 16, v93
    v_and_b32 v25, 0xffff0000, v93
    v_add_f32 v26, v26, v24
    v_add_f32 v27, v27, v25
    v_lshlrev_b32 v24, 16, v94
    v_and_b32 v25, 0xffff0000, v94
    v_add_f32 v26, v26, v24
    v_add_f32 v27, v27, v25
    v_lshlrev_b32 v24, 16, v95
    v_and_b32 v25, 0xffff0000, v95
    v_add_f32 v26, v26, v24
    v_add_f32 v27, v27, v25
    v_lshlrev_b32 v24, 16, v96
    v_and_b32 v25, 0xffff0000, v96
    v_add_f32 v26, v26, v24
    v_add_f32 v27, v27, v25
    v_lshlrev_b32 v24, 16, v97
    v_and_b32 v25, 0xffff0000, v97
    v_add_f32 v26, v26, v24
    v_add_f32 v27, v27, v25
    v_lshlrev_b32 v24, 16, v98
    v_and_b32 v25, 0xffff0000, v98
    v_add_f32 v26, v26, v24
    v_add_f32 v27, v27, v25
    v_lshlrev_b32 v24, 16, v99
    v_and_b32 v25, 0xffff0000, v99
    v_add_f32 v26, v26, v24
    v_add_f32 v27, v27, v25
    v_add_f32 v26, v26, v27
    s_nop 1
    v_add_f32_dpp v26, v26, v26 quad_perm:[1,0,3,2] row_mask:0xf bank_mask:0xf
    s_nop 1
    v_add_f32_dpp v26, v26, v26 quad_perm:[2,3,0,1] row_mask:0xf bank_mask:0xf
    s_nop 1
    v_add_f32_dpp v26, v26, v26 row_half_mirror row_mask:0xf bank_mask:0xf
    v_mul_f32 v26, 0x3ae38e39, v26
    v_mov_b32 v27, 0
    v_lshlrev_b32 v24, 16, v64
    v_and_b32 v25, 0xffff0000, v64
    v_sub_f32 v24, v24, v26
    v_sub_f32 v25, v25, v26
    v_fmac_f32 v27, v24, v24
    v_fmac_f32 v27, v25, v25
    v_lshlrev_b32 v24, 16, v65
    v_and_b32 v25, 0xffff0000, v65
    v_sub_f32 v24, v24, v26
    v_sub_f32 v25, v25, v26
    v_fmac_f32 v27, v24, v24
    v_fmac_f32 v27, v25, v25
    v_lshlrev_b32 v24, 16, v66
    v_and_b32 v25, 0xffff0000, v66
    v_sub_f32 v24, v24, v26
    v_sub_f32 v25, v25, v26
    v_fmac_f32 v27, v24, v24
    v_fmac_f32 v27, v25, v25
    v_lshlrev_b32 v24, 16, v67
    v_and_b32 v25, 0xffff0000, v67
    v_sub_f32 v24, v24, v26
    v_sub_f32 v25, v25, v26
    v_fmac_f32 v27, v24, v24
    v_fmac_f32 v27, v25, v25
    v_lshlrev_b32 v24, 16, v68
    v_and_b32 v25, 0xffff0000, v68
    v_sub_f32 v24, v24, v26
    v_sub_f32 v25, v25, v26
    v_fmac_f32 v27, v24, v24
    v_fmac_f32 v27, v25, v25
    v_lshlrev_b32 v24, 16, v69
    v_and_b32 v25, 0xffff0000, v69
    v_sub_f32 v24, v24, v26
    v_sub_f32 v25, v25, v26
    v_fmac_f32 v27, v24, v24
    v_fmac_f32 v27, v25, v25
    v_lshlrev_b32 v24, 16, v70
    v_and_b32 v25, 0xffff0000, v70
    v_sub_f32 v24, v24, v26
    v_sub_f32 v25, v25, v26
    v_fmac_f32 v27, v24, v24
    v_fmac_f32 v27, v25, v25
    v_lshlrev_b32 v24, 16, v71
    v_and_b32 v25, 0xffff0000, v71
    v_sub_f32 v24, v24, v26
    v_sub_f32 v25, v25, v26
    v_fmac_f32 v27, v24, v24
    v_fmac_f32 v27, v25, v25
    v_lshlrev_b32 v24, 16, v72
    v_and_b32 v25, 0xffff0000, v72
    v_sub_f32 v24, v24, v26
    v_sub_f32 v25, v25, v26
    v_fmac_f32 v27, v24, v24
    v_fmac_f32 v27, v25, v25
    v_lshlrev_b32 v24, 16, v73
    v_and_b32 v25, 0xffff0000, v73
    v_sub_f32 v24, v24, v26
    v_sub_f32 v25, v25, v26
    v_fmac_f32 v27, v24, v24
    v_fmac_f32 v27, v25, v25
    v_lshlrev_b32 v24, 16, v74
    v_and_b32 v25, 0xffff0000, v74
    v_sub_f32 v24, v24, v26
    v_sub_f32 v25, v25, v26
    v_fmac_f32 v27, v24, v24
    v_fmac_f32 v27, v25, v25
    v_lshlrev_b32 v24, 16, v75
    v_and_b32 v25, 0xffff0000, v75
    v_sub_f32 v24, v24, v26
    v_sub_f32 v25, v25, v26
    v_fmac_f32 v27, v24, v24
    v_fmac_f32 v27, v25, v25
    v_lshlrev_b32 v24, 16, v76
    v_and_b32 v25, 0xffff0000, v76
    v_sub_f32 v24, v24, v26
    v_sub_f32 v25, v25, v26
    v_fmac_f32 v27, v24, v24
    v_fmac_f32 v27, v25, v25
    v_lshlrev_b32 v24, 16, v77
    v_and_b32 v25, 0xffff0000, v77
    v_sub_f32 v24, v24, v26
    v_sub_f32 v25, v25, v26
    v_fmac_f32 v27, v24, v24
    v_fmac_f32 v27, v25, v25
    v_lshlrev_b32 v24, 16, v78
    v_and_b32 v25, 0xffff0000, v78
    v_sub_f32 v24, v24, v26
    v_sub_f32 v25, v25, v26
    v_fmac_f32 v27, v24, v24
    v_fmac_f32 v27, v25, v25
    v_lshlrev_b32 v24, 16, v79
    v_and_b32 v25, 0xffff0000, v79
    v_sub_f32 v24, v24, v26
    v_sub_f32 v25, v25, v26
    v_fmac_f32 v27, v24, v24
    v_fmac_f32 v27, v25, v25
    v_lshlrev_b32 v24, 16, v80
    v_and_b32 v25, 0xffff0000, v80
    v_sub_f32 v24, v24, v26
    v_sub_f32 v25, v25, v26
    v_fmac_f32 v27, v24, v24
    v_fmac_f32 v27, v25, v25
    v_lshlrev_b32 v24, 16, v81
    v_and_b32 v25, 0xffff0000, v81
    v_sub_f32 v24, v24, v26
    v_sub_f32 v25, v25, v26
    v_fmac_f32 v27, v24, v24
    v_fmac_f32 v27, v25, v25
    v_lshlrev_b32 v24, 16, v82
    v_and_b32 v25, 0xffff0000, v82
    v_sub_f32 v24, v24, v26
    v_sub_f32 v25, v25, v26
    v_fmac_f32 v27, v24, v24
    v_fmac_f32 v27, v25, v25
    v_lshlrev_b32 v24, 16, v83
    v_and_b32 v25, 0xffff0000, v83
    v_sub_f32 v24, v24, v26
    v_sub_f32 v25, v25, v26
    v_fmac_f32 v27, v24, v24
    v_fmac_f32 v27, v25, v25
    v_lshlrev_b32 v24, 16, v84
    v_and_b32 v25, 0xffff0000, v84
    v_sub_f32 v24, v24, v26
    v_sub_f32 v25, v25, v26
    v_fmac_f32 v27, v24, v24
    v_fmac_f32 v27, v25, v25
    v_lshlrev_b32 v24, 16, v85
    v_and_b32 v25, 0xffff0000, v85
    v_sub_f32 v24, v24, v26
    v_sub_f32 v25, v25, v26
    v_fmac_f32 v27, v24, v24
    v_fmac_f32 v27, v25, v25
    v_lshlrev_b32 v24, 16, v86
    v_and_b32 v25, 0xffff0000, v86
    v_sub_f32 v24, v24, v26
    v_sub_f32 v25, v25, v26
    v_fmac_f32 v27, v24, v24
    v_fmac_f32 v27, v25, v25
    v_lshlrev_b32 v24, 16, v87
    v_and_b32 v25, 0xffff0000, v87
    v_sub_f32 v24, v24, v26
    v_sub_f32 v25, v25, v26
    v_fmac_f32 v27, v24, v24
    v_fmac_f32 v27, v25, v25
    v_lshlrev_b32 v24, 16, v88
    v_and_b32 v25, 0xffff0000, v88
    v_sub_f32 v24, v24, v26
    v_sub_f32 v25, v25, v26
    v_fmac_f32 v27, v24, v24
    v_fmac_f32 v27, v25, v25
    v_lshlrev_b32 v24, 16, v89
    v_and_b32 v25, 0xffff0000, v89
    v_sub_f32 v24, v24, v26
    v_sub_f32 v25, v25, v26
    v_fmac_f32 v27, v24, v24
    v_fmac_f32 v27, v25, v25
    v_lshlrev_b32 v24, 16, v90
    v_and_b32 v25, 0xffff0000, v90
    v_sub_f32 v24, v24, v26
    v_sub_f32 v25, v25, v26
    v_fmac_f32 v27, v24, v24
    v_fmac_f32 v27, v25, v25
    v_lshlrev_b32 v24, 16, v91
    v_and_b32 v25, 0xffff0000, v91
    v_sub_f32 v24, v24, v26
    v_sub_f32 v25, v25, v26
    v_fmac_f32 v27, v24, v24
    v_fmac_f32 v27, v25, v25
    v_lshlrev_b32 v24, 16, v92
    v_and_b32 v25, 0xffff0000, v92
    v_sub_f32 v24, v24, v26
    v_sub_f32 v25, v25, v26
    v_fmac_f32 v27, v24, v24
    v_fmac_f32 v27, v25, v25
    v_lshlrev_b32 v24, 16, v93
    v_and_b32 v25, 0xffff0000, v93
    v_sub_f32 v24, v24, v26
    v_sub_f32 v25, v25, v26
    v_fmac_f32 v27, v24, v24
    v_fmac_f32 v27, v25, v25
    v_lshlrev_b32 v24, 16, v94
    v_and_b32 v25, 0xffff0000, v94
    v_sub_f32 v24, v24, v26
    v_sub_f32 v25, v25, v26
    v_fmac_f32 v27, v24, v24
    v_fmac_f32 v27, v25, v25
    v_lshlrev_b32 v24, 16, v95
    v_and_b32 v25, 0xffff0000, v95
    v_sub_f32 v24, v24, v26
    v_sub_f32 v25, v25, v26
    v_fmac_f32 v27, v24, v24
    v_fmac_f32 v27, v25, v25
    v_lshlrev_b32 v24, 16, v96
    v_and_b32 v25, 0xffff0000, v96
    v_sub_f32 v24, v24, v26
    v_sub_f32 v25, v25, v26
    v_fmac_f32 v27, v24, v24
    v_fmac_f32 v27, v25, v25
    v_lshlrev_b32 v24, 16, v97
    v_and_b32 v25, 0xffff0000, v97
    v_sub_f32 v24, v24, v26
    v_sub_f32 v25, v25, v26
    v_fmac_f32 v27, v24, v24
    v_fmac_f32 v27, v25, v25
    v_lshlrev_b32 v24, 16, v98
    v_and_b32 v25, 0xffff0000, v98
    v_sub_f32 v24, v24, v26
    v_sub_f32 v25, v25, v26
    v_fmac_f32 v27, v24, v24
    v_fmac_f32 v27, v25, v25
    v_lshlrev_b32 v24, 16, v99
    v_and_b32 v25, 0xffff0000, v99
    v_sub_f32 v24, v24, v26
    v_sub_f32 v25, v25, v26
    v_fmac_f32 v27, v24, v24
    v_fmac_f32 v27, v25, v25
    s_nop 1
    v_add_f32_dpp v27, v27, v27 quad_perm:[1,0,3,2] row_mask:0xf bank_mask:0xf
    s_nop 1
    v_add_f32_dpp v27, v27, v27 quad_perm:[2,3,0,1] row_mask:0xf bank_mask:0xf
    s_nop 1
    v_add_f32_dpp v27, v27, v27 row_half_mirror row_mask:0xf bank_mask:0xf
    v_mul_f32 v27, 0x3ae38e39, v27
    v_cvt_pk_bf16_f32 v26, v26, v26
    v_and_b32 v26, 0xffff0000, v26
    v_cvt_pk_bf16_f32 v27, v27, v27
    v_and_b32 v27, 0xffff0000, v27
    v_add_f32 v27, 0x3727c5ac, v27
    v_cvt_pk_bf16_f32 v27, v27, v27
    v_and_b32 v27, 0xffff0000, v27
    v_sqrt_f32 v27, v27
    s_nop 0
    v_cvt_pk_bf16_f32 v27, v27, v27
    v_and_b32 v27, 0xffff0000, v27
    v_rcp_f32 v30, v27
    s_nop 0
    v_lshlrev_b32 v24, 16, v64
    v_and_b32 v25, 0xffff0000, v64
    v_sub_f32 v24, v24, v26
    v_sub_f32 v25, v25, v26
    v_cvt_pk_bf16_f32 v25, v24, v25
    v_lshlrev_b32 v24, 16, v25
    v_and_b32 v25, 0xffff0000, v25
    v_mul_f32 v28, v24, v30
    v_fma_f32 v29, -v28, v27, v24
    v_fmac_f32 v28, v29, v30
    v_mul_f32 v24, v25, v30
    v_fma_f32 v29, -v24, v27, v25
    v_fmac_f32 v24, v29, v30
    v_cvt_pk_bf16_f32 v64, v28, v24
    v_lshlrev_b32 v24, 16, v65
    v_and_b32 v25, 0xffff0000, v65
    v_sub_f32 v24, v24, v26
    v_sub_f32 v25, v25, v26
    v_cvt_pk_bf16_f32 v25, v24, v25
    v_lshlrev_b32 v24, 16, v25
    v_and_b32 v25, 0xffff0000, v25
    v_mul_f32 v28, v24, v30
    v_fma_f32 v29, -v28, v27, v24
    v_fmac_f32 v28, v29, v30
    v_mul_f32 v24, v25, v30
    v_fma_f32 v29, -v24, v27, v25
    v_fmac_f32 v24, v29, v30
    v_cvt_pk_bf16_f32 v65, v28, v24
    v_lshlrev_b32 v24, 16, v66
    v_and_b32 v25, 0xffff0000, v66
    v_sub_f32 v24, v24, v26
    v_sub_f32 v25, v25, v26
    v_cvt_pk_bf16_f32 v25, v24, v25
    v_lshlrev_b32 v24, 16, v25
    v_and_b32 v25, 0xffff0000, v25
    v_mul_f32 v28, v24, v30
    v_fma_f32 v29, -v28, v27, v24
    v_fmac_f32 v28, v29, v30
    v_mul_f32 v24, v25, v30
    v_fma_f32 v29, -v24, v27, v25
    v_fmac_f32 v24, v29, v30
    v_cvt_pk_bf16_f32 v66, v28, v24
    v_lshlrev_b32 v24, 16, v67
    v_and_b32 v25, 0xffff0000, v67
    v_sub_f32 v24, v24, v26
    v_sub_f32 v25, v25, v26
    v_cvt_pk_bf16_f32 v25, v24, v25
    v_lshlrev_b32 v24, 16, v25
    v_and_b32 v25, 0xffff0000, v25
    v_mul_f32 v28, v24, v30
    v_fma_f32 v29, -v28, v27, v24
    v_fmac_f32 v28, v29, v30
    v_mul_f32 v24, v25, v30
    v_fma_f32 v29, -v24, v27, v25
    v_fmac_f32 v24, v29, v30
    v_cvt_pk_bf16_f32 v67, v28, v24
    v_lshlrev_b32 v24, 16, v68
    v_and_b32 v25, 0xffff0000, v68
    v_sub_f32 v24, v24, v26
    v_sub_f32 v25, v25, v26
    v_cvt_pk_bf16_f32 v25, v24, v25
    v_lshlrev_b32 v24, 16, v25
    v_and_b32 v25, 0xffff0000, v25
    v_mul_f32 v28, v24, v30
    v_fma_f32 v29, -v28, v27, v24
    v_fmac_f32 v28, v29, v30
    v_mul_f32 v24, v25, v30
    v_fma_f32 v29, -v24, v27, v25
    v_fmac_f32 v24, v29, v30
    v_cvt_pk_bf16_f32 v68, v28, v24
    v_lshlrev_b32 v24, 16, v69
    v_and_b32 v25, 0xffff0000, v69
    v_sub_f32 v24, v24, v26
    v_sub_f32 v25, v25, v26
    v_cvt_pk_bf16_f32 v25, v24, v25
    v_lshlrev_b32 v24, 16, v25
    v_and_b32 v25, 0xffff0000, v25
    v_mul_f32 v28, v24, v30
    v_fma_f32 v29, -v28, v27, v24
    v_fmac_f32 v28, v29, v30
    v_mul_f32 v24, v25, v30
    v_fma_f32 v29, -v24, v27, v25
    v_fmac_f32 v24, v29, v30
    v_cvt_pk_bf16_f32 v69, v28, v24
    v_lshlrev_b32 v24, 16, v70
    v_and_b32 v25, 0xffff0000, v70
    v_sub_f32 v24, v24, v26
    v_sub_f32 v25, v25, v26
    v_cvt_pk_bf16_f32 v25, v24, v25
    v_lshlrev_b32 v24, 16, v25
    v_and_b32 v25, 0xffff0000, v25
    v_mul_f32 v28, v24, v30
    v_fma_f32 v29, -v28, v27, v24
    v_fmac_f32 v28, v29, v30
    v_mul_f32 v24, v25, v30
    v_fma_f32 v29, -v24, v27, v25
    v_fmac_f32 v24, v29, v30
    v_cvt_pk_bf16_f32 v70, v28, v24
    v_lshlrev_b32 v24, 16, v71
    v_and_b32 v25, 0xffff0000, v71
    v_sub_f32 v24, v24, v26
    v_sub_f32 v25, v25, v26
    v_cvt_pk_bf16_f32 v25, v24, v25
    v_lshlrev_b32 v24, 16, v25
    v_and_b32 v25, 0xffff0000, v25
    v_mul_f32 v28, v24, v30
    v_fma_f32 v29, -v28, v27, v24
    v_fmac_f32 v28, v29, v30
    v_mul_f32 v24, v25, v30
    v_fma_f32 v29, -v24, v27, v25
    v_fmac_f32 v24, v29, v30
    v_cvt_pk_bf16_f32 v71, v28, v24
    v_lshlrev_b32 v24, 16, v72
    v_and_b32 v25, 0xffff0000, v72
    v_sub_f32 v24, v24, v26
    v_sub_f32 v25, v25, v26
    v_cvt_pk_bf16_f32 v25, v24, v25
    v_lshlrev_b32 v24, 16, v25
    v_and_b32 v25, 0xffff0000, v25
    v_mul_f32 v28, v24, v30
    v_fma_f32 v29, -v28, v27, v24
    v_fmac_f32 v28, v29, v30
    v_mul_f32 v24, v25, v30
    v_fma_f32 v29, -v24, v27, v25
    v_fmac_f32 v24, v29, v30
    v_cvt_pk_bf16_f32 v72, v28, v24
    v_lshlrev_b32 v24, 16, v73
    v_and_b32 v25, 0xffff0000, v73
    v_sub_f32 v24, v24, v26
    v_sub_f32 v25, v25, v26
    v_cvt_pk_bf16_f32 v25, v24, v25
    v_lshlrev_b32 v24, 16, v25
    v_and_b32 v25, 0xffff0000, v25
    v_mul_f32 v28, v24, v30
    v_fma_f32 v29, -v28, v27, v24
    v_fmac_f32 v28, v29, v30
    v_mul_f32 v24, v25, v30
    v_fma_f32 v29, -v24, v27, v25
    v_fmac_f32 v24, v29, v30
    v_cvt_pk_bf16_f32 v73, v28, v24
    v_lshlrev_b32 v24, 16, v74
    v_and_b32 v25, 0xffff0000, v74
    v_sub_f32 v24, v24, v26
    v_sub_f32 v25, v25, v26
    v_cvt_pk_bf16_f32 v25, v24, v25
    v_lshlrev_b32 v24, 16, v25
    v_and_b32 v25, 0xffff0000, v25
    v_mul_f32 v28, v24, v30
    v_fma_f32 v29, -v28, v27, v24
    v_fmac_f32 v28, v29, v30
    v_mul_f32 v24, v25, v30
    v_fma_f32 v29, -v24, v27, v25
    v_fmac_f32 v24, v29, v30
    v_cvt_pk_bf16_f32 v74, v28, v24
    v_lshlrev_b32 v24, 16, v75
    v_and_b32 v25, 0xffff0000, v75
    v_sub_f32 v24, v24, v26
    v_sub_f32 v25, v25, v26
    v_cvt_pk_bf16_f32 v25, v24, v25
    v_lshlrev_b32 v24, 16, v25
    v_and_b32 v25, 0xffff0000, v25
    v_mul_f32 v28, v24, v30
    v_fma_f32 v29, -v28, v27, v24
    v_fmac_f32 v28, v29, v30
    v_mul_f32 v24, v25, v30
    v_fma_f32 v29, -v24, v27, v25
    v_fmac_f32 v24, v29, v30
    v_cvt_pk_bf16_f32 v75, v28, v24
    v_lshlrev_b32 v24, 16, v76
    v_and_b32 v25, 0xffff0000, v76
    v_sub_f32 v24, v24, v26
    v_sub_f32 v25, v25, v26
    v_cvt_pk_bf16_f32 v25, v24, v25
    v_lshlrev_b32 v24, 16, v25
    v_and_b32 v25, 0xffff0000, v25
    v_mul_f32 v28, v24, v30
    v_fma_f32 v29, -v28, v27, v24
    v_fmac_f32 v28, v29, v30
    v_mul_f32 v24, v25, v30
    v_fma_f32 v29, -v24, v27, v25
    v_fmac_f32 v24, v29, v30
    v_cvt_pk_bf16_f32 v76, v28, v24
    v_lshlrev_b32 v24, 16, v77
    v_and_b32 v25, 0xffff0000, v77
    v_sub_f32 v24, v24, v26
    v_sub_f32 v25, v25, v26
    v_cvt_pk_bf16_f32 v25, v24, v25
    v_lshlrev_b32 v24, 16, v25
    v_and_b32 v25, 0xffff0000, v25
    v_mul_f32 v28, v24, v30
    v_fma_f32 v29, -v28, v27, v24
    v_fmac_f32 v28, v29, v30
    v_mul_f32 v24, v25, v30
    v_fma_f32 v29, -v24, v27, v25
    v_fmac_f32 v24, v29, v30
    v_cvt_pk_bf16_f32 v77, v28, v24
    v_lshlrev_b32 v24, 16, v78
    v_and_b32 v25, 0xffff0000, v78
    v_sub_f32 v24, v24, v26
    v_sub_f32 v25, v25, v26
    v_cvt_pk_bf16_f32 v25, v24, v25
    v_lshlrev_b32 v24, 16, v25
    v_and_b32 v25, 0xffff0000, v25
    v_mul_f32 v28, v24, v30
    v_fma_f32 v29, -v28, v27, v24
    v_fmac_f32 v28, v29, v30
    v_mul_f32 v24, v25, v30
    v_fma_f32 v29, -v24, v27, v25
    v_fmac_f32 v24, v29, v30
    v_cvt_pk_bf16_f32 v78, v28, v24
    v_lshlrev_b32 v24, 16, v79
    v_and_b32 v25, 0xffff0000, v79
    v_sub_f32 v24, v24, v26
    v_sub_f32 v25, v25, v26
    v_cvt_pk_bf16_f32 v25, v24, v25
    v_lshlrev_b32 v24, 16, v25
    v_and_b32 v25, 0xffff0000, v25
    v_mul_f32 v28, v24, v30
    v_fma_f32 v29, -v28, v27, v24
    v_fmac_f32 v28, v29, v30
    v_mul_f32 v24, v25, v30
    v_fma_f32 v29, -v24, v27, v25
    v_fmac_f32 v24, v29, v30
    v_cvt_pk_bf16_f32 v79, v28, v24
    v_lshlrev_b32 v24, 16, v80
    v_and_b32 v25, 0xffff0000, v80
    v_sub_f32 v24, v24, v26
    v_sub_f32 v25, v25, v26
    v_cvt_pk_bf16_f32 v25, v24, v25
    v_lshlrev_b32 v24, 16, v25
    v_and_b32 v25, 0xffff0000, v25
    v_mul_f32 v28, v24, v30
    v_fma_f32 v29, -v28, v27, v24
    v_fmac_f32 v28, v29, v30
    v_mul_f32 v24, v25, v30
    v_fma_f32 v29, -v24, v27, v25
    v_fmac_f32 v24, v29, v30
    v_cvt_pk_bf16_f32 v80, v28, v24
    v_lshlrev_b32 v24, 16, v81
    v_and_b32 v25, 0xffff0000, v81
    v_sub_f32 v24, v24, v26
    v_sub_f32 v25, v25, v26
    v_cvt_pk_bf16_f32 v25, v24, v25
    v_lshlrev_b32 v24, 16, v25
    v_and_b32 v25, 0xffff0000, v25
    v_mul_f32 v28, v24, v30
    v_fma_f32 v29, -v28, v27, v24
    v_fmac_f32 v28, v29, v30
    v_mul_f32 v24, v25, v30
    v_fma_f32 v29, -v24, v27, v25
    v_fmac_f32 v24, v29, v30
    v_cvt_pk_bf16_f32 v81, v28, v24
    v_lshlrev_b32 v24, 16, v82
    v_and_b32 v25, 0xffff0000, v82
    v_sub_f32 v24, v24, v26
    v_sub_f32 v25, v25, v26
    v_cvt_pk_bf16_f32 v25, v24, v25
    v_lshlrev_b32 v24, 16, v25
    v_and_b32 v25, 0xffff0000, v25
    v_mul_f32 v28, v24, v30
    v_fma_f32 v29, -v28, v27, v24
    v_fmac_f32 v28, v29, v30
    v_mul_f32 v24, v25, v30
    v_fma_f32 v29, -v24, v27, v25
    v_fmac_f32 v24, v29, v30
    v_cvt_pk_bf16_f32 v82, v28, v24
    v_lshlrev_b32 v24, 16, v83
    v_and_b32 v25, 0xffff0000, v83
    v_sub_f32 v24, v24, v26
    v_sub_f32 v25, v25, v26
    v_cvt_pk_bf16_f32 v25, v24, v25
    v_lshlrev_b32 v24, 16, v25
    v_and_b32 v25, 0xffff0000, v25
    v_mul_f32 v28, v24, v30
    v_fma_f32 v29, -v28, v27, v24
    v_fmac_f32 v28, v29, v30
    v_mul_f32 v24, v25, v30
    v_fma_f32 v29, -v24, v27, v25
    v_fmac_f32 v24, v29, v30
    v_cvt_pk_bf16_f32 v83, v28, v24
    v_lshlrev_b32 v24, 16, v84
    v_and_b32 v25, 0xffff0000, v84
    v_sub_f32 v24, v24, v26
    v_sub_f32 v25, v25, v26
    v_cvt_pk_bf16_f32 v25, v24, v25
    v_lshlrev_b32 v24, 16, v25
    v_and_b32 v25, 0xffff0000, v25
    v_mul_f32 v28, v24, v30
    v_fma_f32 v29, -v28, v27, v24
    v_fmac_f32 v28, v29, v30
    v_mul_f32 v24, v25, v30
    v_fma_f32 v29, -v24, v27, v25
    v_fmac_f32 v24, v29, v30
    v_cvt_pk_bf16_f32 v84, v28, v24
    v_lshlrev_b32 v24, 16, v85
    v_and_b32 v25, 0xffff0000, v85
    v_sub_f32 v24, v24, v26
    v_sub_f32 v25, v25, v26
    v_cvt_pk_bf16_f32 v25, v24, v25
    v_lshlrev_b32 v24, 16, v25
    v_and_b32 v25, 0xffff0000, v25
    v_mul_f32 v28, v24, v30
    v_fma_f32 v29, -v28, v27, v24
    v_fmac_f32 v28, v29, v30
    v_mul_f32 v24, v25, v30
    v_fma_f32 v29, -v24, v27, v25
    v_fmac_f32 v24, v29, v30
    v_cvt_pk_bf16_f32 v85, v28, v24
    v_lshlrev_b32 v24, 16, v86
    v_and_b32 v25, 0xffff0000, v86
    v_sub_f32 v24, v24, v26
    v_sub_f32 v25, v25, v26
    v_cvt_pk_bf16_f32 v25, v24, v25
    v_lshlrev_b32 v24, 16, v25
    v_and_b32 v25, 0xffff0000, v25
    v_mul_f32 v28, v24, v30
    v_fma_f32 v29, -v28, v27, v24
    v_fmac_f32 v28, v29, v30
    v_mul_f32 v24, v25, v30
    v_fma_f32 v29, -v24, v27, v25
    v_fmac_f32 v24, v29, v30
    v_cvt_pk_bf16_f32 v86, v28, v24
    v_lshlrev_b32 v24, 16, v87
    v_and_b32 v25, 0xffff0000, v87
    v_sub_f32 v24, v24, v26
    v_sub_f32 v25, v25, v26
    v_cvt_pk_bf16_f32 v25, v24, v25
    v_lshlrev_b32 v24, 16, v25
    v_and_b32 v25, 0xffff0000, v25
    v_mul_f32 v28, v24, v30
    v_fma_f32 v29, -v28, v27, v24
    v_fmac_f32 v28, v29, v30
    v_mul_f32 v24, v25, v30
    v_fma_f32 v29, -v24, v27, v25
    v_fmac_f32 v24, v29, v30
    v_cvt_pk_bf16_f32 v87, v28, v24
    v_lshlrev_b32 v24, 16, v88
    v_and_b32 v25, 0xffff0000, v88
    v_sub_f32 v24, v24, v26
    v_sub_f32 v25, v25, v26
    v_cvt_pk_bf16_f32 v25, v24, v25
    v_lshlrev_b32 v24, 16, v25
    v_and_b32 v25, 0xffff0000, v25
    v_mul_f32 v28, v24, v30
    v_fma_f32 v29, -v28, v27, v24
    v_fmac_f32 v28, v29, v30
    v_mul_f32 v24, v25, v30
    v_fma_f32 v29, -v24, v27, v25
    v_fmac_f32 v24, v29, v30
    v_cvt_pk_bf16_f32 v88, v28, v24
    v_lshlrev_b32 v24, 16, v89
    v_and_b32 v25, 0xffff0000, v89
    v_sub_f32 v24, v24, v26
    v_sub_f32 v25, v25, v26
    v_cvt_pk_bf16_f32 v25, v24, v25
    v_lshlrev_b32 v24, 16, v25
    v_and_b32 v25, 0xffff0000, v25
    v_mul_f32 v28, v24, v30
    v_fma_f32 v29, -v28, v27, v24
    v_fmac_f32 v28, v29, v30
    v_mul_f32 v24, v25, v30
    v_fma_f32 v29, -v24, v27, v25
    v_fmac_f32 v24, v29, v30
    v_cvt_pk_bf16_f32 v89, v28, v24
    v_lshlrev_b32 v24, 16, v90
    v_and_b32 v25, 0xffff0000, v90
    v_sub_f32 v24, v24, v26
    v_sub_f32 v25, v25, v26
    v_cvt_pk_bf16_f32 v25, v24, v25
    v_lshlrev_b32 v24, 16, v25
    v_and_b32 v25, 0xffff0000, v25
    v_mul_f32 v28, v24, v30
    v_fma_f32 v29, -v28, v27, v24
    v_fmac_f32 v28, v29, v30
    v_mul_f32 v24, v25, v30
    v_fma_f32 v29, -v24, v27, v25
    v_fmac_f32 v24, v29, v30
    v_cvt_pk_bf16_f32 v90, v28, v24
    v_lshlrev_b32 v24, 16, v91
    v_and_b32 v25, 0xffff0000, v91
    v_sub_f32 v24, v24, v26
    v_sub_f32 v25, v25, v26
    v_cvt_pk_bf16_f32 v25, v24, v25
    v_lshlrev_b32 v24, 16, v25
    v_and_b32 v25, 0xffff0000, v25
    v_mul_f32 v28, v24, v30
    v_fma_f32 v29, -v28, v27, v24
    v_fmac_f32 v28, v29, v30
    v_mul_f32 v24, v25, v30
    v_fma_f32 v29, -v24, v27, v25
    v_fmac_f32 v24, v29, v30
    v_cvt_pk_bf16_f32 v91, v28, v24
    v_lshlrev_b32 v24, 16, v92
    v_and_b32 v25, 0xffff0000, v92
    v_sub_f32 v24, v24, v26
    v_sub_f32 v25, v25, v26
    v_cvt_pk_bf16_f32 v25, v24, v25
    v_lshlrev_b32 v24, 16, v25
    v_and_b32 v25, 0xffff0000, v25
    v_mul_f32 v28, v24, v30
    v_fma_f32 v29, -v28, v27, v24
    v_fmac_f32 v28, v29, v30
    v_mul_f32 v24, v25, v30
    v_fma_f32 v29, -v24, v27, v25
    v_fmac_f32 v24, v29, v30
    v_cvt_pk_bf16_f32 v92, v28, v24
    v_lshlrev_b32 v24, 16, v93
    v_and_b32 v25, 0xffff0000, v93
    v_sub_f32 v24, v24, v26
    v_sub_f32 v25, v25, v26
    v_cvt_pk_bf16_f32 v25, v24, v25
    v_lshlrev_b32 v24, 16, v25
    v_and_b32 v25, 0xffff0000, v25
    v_mul_f32 v28, v24, v30
    v_fma_f32 v29, -v28, v27, v24
    v_fmac_f32 v28, v29, v30
    v_mul_f32 v24, v25, v30
    v_fma_f32 v29, -v24, v27, v25
    v_fmac_f32 v24, v29, v30
    v_cvt_pk_bf16_f32 v93, v28, v24
    v_lshlrev_b32 v24, 16, v94
    v_and_b32 v25, 0xffff0000, v94
    v_sub_f32 v24, v24, v26
    v_sub_f32 v25, v25, v26
    v_cvt_pk_bf16_f32 v25, v24, v25
    v_lshlrev_b32 v24, 16, v25
    v_and_b32 v25, 0xffff0000, v25
    v_mul_f32 v28, v24, v30
    v_fma_f32 v29, -v28, v27, v24
    v_fmac_f32 v28, v29, v30
    v_mul_f32 v24, v25, v30
    v_fma_f32 v29, -v24, v27, v25
    v_fmac_f32 v24, v29, v30
    v_cvt_pk_bf16_f32 v94, v28, v24
    v_lshlrev_b32 v24, 16, v95
    v_and_b32 v25, 0xffff0000, v95
    v_sub_f32 v24, v24, v26
    v_sub_f32 v25, v25, v26
    v_cvt_pk_bf16_f32 v25, v24, v25
    v_lshlrev_b32 v24, 16, v25
    v_and_b32 v25, 0xffff0000, v25
    v_mul_f32 v28, v24, v30
    v_fma_f32 v29, -v28, v27, v24
    v_fmac_f32 v28, v29, v30
    v_mul_f32 v24, v25, v30
    v_fma_f32 v29, -v24, v27, v25
    v_fmac_f32 v24, v29, v30
    v_cvt_pk_bf16_f32 v95, v28, v24
    v_lshlrev_b32 v24, 16, v96
    v_and_b32 v25, 0xffff0000, v96
    v_sub_f32 v24, v24, v26
    v_sub_f32 v25, v25, v26
    v_cvt_pk_bf16_f32 v25, v24, v25
    v_lshlrev_b32 v24, 16, v25
    v_and_b32 v25, 0xffff0000, v25
    v_mul_f32 v28, v24, v30
    v_fma_f32 v29, -v28, v27, v24
    v_fmac_f32 v28, v29, v30
    v_mul_f32 v24, v25, v30
    v_fma_f32 v29, -v24, v27, v25
    v_fmac_f32 v24, v29, v30
    v_cvt_pk_bf16_f32 v96, v28, v24
    v_lshlrev_b32 v24, 16, v97
    v_and_b32 v25, 0xffff0000, v97
    v_sub_f32 v24, v24, v26
    v_sub_f32 v25, v25, v26
    v_cvt_pk_bf16_f32 v25, v24, v25
    v_lshlrev_b32 v24, 16, v25
    v_and_b32 v25, 0xffff0000, v25
    v_mul_f32 v28, v24, v30
    v_fma_f32 v29, -v28, v27, v24
    v_fmac_f32 v28, v29, v30
    v_mul_f32 v24, v25, v30
    v_fma_f32 v29, -v24, v27, v25
    v_fmac_f32 v24, v29, v30
    v_cvt_pk_bf16_f32 v97, v28, v24
    v_lshlrev_b32 v24, 16, v98
    v_and_b32 v25, 0xffff0000, v98
    v_sub_f32 v24, v24, v26
    v_sub_f32 v25, v25, v26
    v_cvt_pk_bf16_f32 v25, v24, v25
    v_lshlrev_b32 v24, 16, v25
    v_and_b32 v25, 0xffff0000, v25
    v_mul_f32 v28, v24, v30
    v_fma_f32 v29, -v28, v27, v24
    v_fmac_f32 v28, v29, v30
    v_mul_f32 v24, v25, v30
    v_fma_f32 v29, -v24, v27, v25
    v_fmac_f32 v24, v29, v30
    v_cvt_pk_bf16_f32 v98, v28, v24
    v_lshlrev_b32 v24, 16, v99
    v_and_b32 v25, 0xffff0000, v99
    v_sub_f32 v24, v24, v26
    v_sub_f32 v25, v25, v26
    v_cvt_pk_bf16_f32 v25, v24, v25
    v_lshlrev_b32 v24, 16, v25
    v_and_b32 v25, 0xffff0000, v25
    v_mul_f32 v28, v24, v30
    v_fma_f32 v29, -v28, v27, v24
    v_fmac_f32 v28, v29, v30
    v_mul_f32 v24, v25, v30
    v_fma_f32 v29, -v24, v27, v25
    v_fmac_f32 v24, v29, v30
    v_cvt_pk_bf16_f32 v99, v28, v24
    ds_write_b128 v4, v[64:67] offset:4096
    ds_write_b128 v4, v[68:71] offset:4224
    ds_write_b128 v4, v[72:75] offset:4352
    ds_write_b128 v4, v[76:79] offset:4480
    ds_write_b128 v4, v[80:83] offset:4608
    ds_write_b128 v4, v[84:87] offset:4736
    ds_write_b128 v4, v[88:91] offset:4864
    ds_write_b128 v4, v[92:95] offset:4992
    ds_write_b128 v4, v[96:99] offset:5120
    s_add_u32 s36, s20, s54
    s_addc_u32 s37, s21, 0
    s_and_b32 s37, s37, 0xffff
    s_mov_b32 s38, 0
    s_mov_b32 s39, 0x20000
    s_sub_u32 s38, 5308416, s54
    v_mul_u32_u24 v3, 73728, v1
    v_lshl_add_u32 v3, v2, 3, v3
    v_and_b32 v4, 7, v0
    v_mul_u32_u24 v4, 1168, v4
    v_lshl_add_u32 v4, v1, 4, v4
    v_mov_b32 v32, 0
    v_mov_b32 v33, 0
    v_mov_b32 v34, 0
    v_mov_b32 v35, 0
    v_mov_b32 v36, 0
    v_mov_b32 v37, 0
    v_mov_b32 v38, 0
    v_mov_b32 v39, 0
    v_mov_b32 v40, 0
    v_mov_b32 v41, 0
    v_mov_b32 v42, 0
    v_mov_b32 v43, 0
    v_mov_b32 v44, 0
    v_mov_b32 v45, 0
    v_mov_b32 v46, 0
    v_mov_b32 v47, 0
    s_waitcnt lgkmcnt(0)
    s_mov_b32 s56, 0
    s_waitcnt vmcnt(7)
    buffer_load_dwordx2 v[64:65], v3, s[36:39], s56 offen nt
    s_add_u32 s56, s56, 9216
    s_waitcnt vmcnt(7)
    buffer_load_dwordx2 v[66:67], v3, s[36:39], s56 offen nt
    s_add_u32 s56, s56, 9216
    s_waitcnt vmcnt(7)
    buffer_load_dwordx2 v[68:69], v3, s[36:39], s56 offen nt
    s_add_u32 s56, s56, 9216
    s_waitcnt vmcnt(7)
    buffer_load_dwordx2 v[70:71], v3, s[36:39], s56 offen nt
    s_add_u32 s56, s56, 9216
    s_waitcnt vmcnt(7)
    buffer_load_dwordx2 v[72:73], v3, s[36:39], s56 offen nt
    s_add_u32 s56, s56, 9216
    s_waitcnt vmcnt(7)
    buffer_load_dwordx2 v[74:75], v3, s[36:39], s56 offen nt
    s_add_u32 s56, s56, 9216
    s_waitcnt vmcnt(7)
    buffer_load_dwordx2 v[76:77], v3, s[36:39], s56 offen nt
    s_add_u32 s56, s56, 9216
    s_waitcnt vmcnt(7)
    buffer_load_dwordx2 v[78:79], v3, s[36:39], s56 offen nt
    s_add_u32 s56, s56, 230400
    s_mov_b32 s57, 9
L_g1:
    s_waitcnt vmcnt(7)
    buffer_load_dwordx2 v[80:81], v3, s[36:39], s56 offen nt
    s_add_u32 s56, s56, 9216
    s_waitcnt vmcnt(7)
    buffer_load_dwordx2 v[82:83], v3, s[36:39], s56 offen nt
    s_add_u32 s56, s56, 9216
    s_waitcnt vmcnt(7)
    buffer_load_dwordx2 v[84:85], v3, s[36:39], s56 offen nt
    s_add_u32 s56, s56, 9216
    s_waitcnt vmcnt(7)
    buffer_load_dwordx2 v[86:87], v3, s[36:39], s56 offen nt
    s_add_u32 s56, s56, 9216
    s_waitcnt vmcnt(7)
    buffer_load_dwordx2 v[88:89], v3, s[36:39], s56 offen nt
    s_add_u32 s56, s56, 9216
    s_waitcnt vmcnt(7)
    buffer_load_dwordx2 v[90:91], v3, s[36:39], s56 offen nt
    s_add_u32 s56, s56, 9216
    s_waitcnt vmcnt(7)
    buffer_load_dwordx2 v[92:93], v3, s[36:39], s56 offen nt
    s_add_u32 s56, s56, 9216
    s_waitcnt vmcnt(7)
    buffer_load_dwordx2 v[94:95], v3, s[36:39], s56 offen nt
    s_add_u32 s56, s56, 230400
    ds_read_b128 v[56:59], v4 offset:4096
    s_waitcnt vmcnt(8)
    v_perm_b32 v96, v66, v64, s66
    v_perm_b32 v100, v66, v64, s67
    v_perm_b32 v97, v70, v68, s66
    v_perm_b32 v101, v70, v68, s67
    v_perm_b32 v98, v74, v72, s66
    v_perm_b32 v102, v74, v72, s67
    v_perm_b32 v99, v78, v76, s66
    v_perm_b32 v103, v78, v76, s67
    v_perm_b32 v104, v67, v65, s66
    v_perm_b32 v108, v67, v65, s67
    v_perm_b32 v105, v71, v69, s66
    v_perm_b32 v109, v71, v69, s67
    v_perm_b32 v106, v75, v73, s66
    v_perm_b32 v110, v75, v73, s67
    v_perm_b32 v107, v79, v77, s66
    v_perm_b32 v111, v79, v77, s67
    s_waitcnt lgkmcnt(0)
    s_nop 0
    v_mfma_f32_16x16x32_bf16 v[32:35], v[56:59], v[96:99], v[32:35]
    v_mfma_f32_16x16x32_bf16 v[36:39], v[56:59], v[100:103], v[36:39]
    v_mfma_f32_16x16x32_bf16 v[40:43], v[56:59], v[104:107], v[40:43]
    v_mfma_f32_16x16x32_bf16 v[44:47], v[56:59], v[108:111], v[44:47]
    s_waitcnt vmcnt(7)
    buffer_load_dwordx2 v[64:65], v3, s[36:39], s56 offen nt
    s_add_u32 s56, s56, 9216
    s_waitcnt vmcnt(7)
    buffer_load_dwordx2 v[66:67], v3, s[36:39], s56 offen nt
    s_add_u32 s56, s56, 9216
    s_waitcnt vmcnt(7)
    buffer_load_dwordx2 v[68:69], v3, s[36:39], s56 offen nt
    s_add_u32 s56, s56, 9216
    s_waitcnt vmcnt(7)
    buffer_load_dwordx2 v[70:71], v3, s[36:39], s56 offen nt
    s_add_u32 s56, s56, 9216
    s_waitcnt vmcnt(7)
    buffer_load_dwordx2 v[72:73], v3, s[36:39], s56 offen nt
    s_add_u32 s56, s56, 9216
    s_waitcnt vmcnt(7)
    buffer_load_dwordx2 v[74:75], v3, s[36:39], s56 offen nt
    s_add_u32 s56, s56, 9216
    s_waitcnt vmcnt(7)
    buffer_load_dwordx2 v[76:77], v3, s[36:39], s56 offen nt
    s_add_u32 s56, s56, 9216
    s_waitcnt vmcnt(7)
    buffer_load_dwordx2 v[78:79], v3, s[36:39], s56 offen nt
    s_add_u32 s56, s56, 230400
    ds_read_b128 v[56:59], v4 offset:4160
    s_waitcnt vmcnt(8)
    v_perm_b32 v96, v82, v80, s66
    v_perm_b32 v100, v82, v80, s67
    v_perm_b32 v97, v86, v84, s66
    v_perm_b32 v101, v86, v84, s67
    v_perm_b32 v98, v90, v88, s66
    v_perm_b32 v102, v90, v88, s67
    v_perm_b32 v99, v94, v92, s66
    v_perm_b32 v103, v94, v92, s67
    v_perm_b32 v104, v83, v81, s66
    v_perm_b32 v108, v83, v81, s67
    v_perm_b32 v105, v87, v85, s66
    v_perm_b32 v109, v87, v85, s67
    v_perm_b32 v106, v91, v89, s66
    v_perm_b32 v110, v91, v89, s67
    v_perm_b32 v107, v95, v93, s66
    v_perm_b32 v111, v95, v93, s67
    s_waitcnt lgkmcnt(0)
    s_nop 0
    v_mfma_f32_16x16x32_bf16 v[32:35], v[56:59], v[96:99], v[32:35]
    v_mfma_f32_16x16x32_bf16 v[36:39], v[56:59], v[100:103], v[36:39]
    v_mfma_f32_16x16x32_bf16 v[40:43], v[56:59], v[104:107], v[40:43]
    v_mfma_f32_16x16x32_bf16 v[44:47], v[56:59], v[108:111], v[44:47]
    v_add_u32 v4, 128, v4
    s_sub_u32 s57, s57, 1
    s_cmp_lg_u32 s57, 0
    s_cbranch_scc1 L_g1
    s_waitcnt vmcnt(0)
    s_nop 3
    v_cndmask_b32 v48, v32, v34, s[70:71]
    v_cndmask_b32 v49, v36, v38, s[70:71]
    v_cndmask_b32 v50, v40, v42, s[70:71]
    v_cndmask_b32 v51, v44, v46, s[70:71]
    v_cndmask_b32 v52, v33, v35, s[70:71]
    v_cndmask_b32 v53, v37, v39, s[70:71]
    v_cndmask_b32 v54, v41, v43, s[70:71]
    v_cndmask_b32 v55, v45, v47, s[70:71]
    v_lshlrev_b32 v12, 16, v8
    v_and_b32 v13, 0xffff0000, v8
    v_lshlrev_b32 v14, 16, v9
    v_and_b32 v15, 0xffff0000, v9
    s_mov_b32 s60, 0xbdd2d3e8
    v_mov_b32 v29, 0xc0135761
    v_cvt_pk_bf16_f32 v48, v48, v48
    v_and_b32 v48, 0xffff0000, v48
    v_add_f32 v48, v48, v12
    v_cvt_pk_bf16_f32 v48, v48, v48
    v_and_b32 v48, 0xffff0000, v48
    v_mul_f32 v24, v48, v48
    v_fma_f32 v24, v24, s60, v29
    v_mul_f32 v24, v24, v48
    v_exp_f32 v25, v24
    s_nop 0
    v_add_f32 v25, 1.0, v25
    v_rcp_f32 v25, v25
    s_nop 0
    v_mul_f32 v48, v48, v25
    v_cvt_pk_bf16_f32 v49, v49, v49
    v_and_b32 v49, 0xffff0000, v49
    v_add_f32 v49, v49, v13
    v_cvt_pk_bf16_f32 v49, v49, v49
    v_and_b32 v49, 0xffff0000, v49
    v_mul_f32 v24, v49, v49
    v_fma_f32 v24, v24, s60, v29
    v_mul_f32 v24, v24, v49
    v_exp_f32 v25, v24
    s_nop 0
    v_add_f32 v25, 1.0, v25
    v_rcp_f32 v25, v25
    s_nop 0
    v_mul_f32 v49, v49, v25
    v_cvt_pk_bf16_f32 v50, v50, v50
    v_and_b32 v50, 0xffff0000, v50
    v_add_f32 v50, v50, v14
    v_cvt_pk_bf16_f32 v50, v50, v50
    v_and_b32 v50, 0xffff0000, v50
    v_mul_f32 v24, v50, v50
    v_fma_f32 v24, v24, s60, v29
    v_mul_f32 v24, v24, v50
    v_exp_f32 v25, v24
    s_nop 0
    v_add_f32 v25, 1.0, v25
    v_rcp_f32 v25, v25
    s_nop 0
    v_mul_f32 v50, v50, v25
    v_cvt_pk_bf16_f32 v51, v51, v51
    v_and_b32 v51, 0xffff0000, v51
    v_add_f32 v51, v51, v15
    v_cvt_pk_bf16_f32 v51, v51, v51
    v_and_b32 v51, 0xffff0000, v51
    v_mul_f32 v24, v51, v51
    v_fma_f32 v24, v24, s60, v29
    v_mul_f32 v24, v24, v51
    v_exp_f32 v25, v24
    s_nop 0
    v_add_f32 v25, 1.0, v25
    v_rcp_f32 v25, v25
    s_nop 0
    v_mul_f32 v51, v51, v25
    v_cvt_pk_bf16_f32 v52, v52, v52
    v_and_b32 v52, 0xffff0000, v52
    v_add_f32 v52, v52, v12
    v_cvt_pk_bf16_f32 v52, v52, v52
    v_and_b32 v52, 0xffff0000, v52
    v_mul_f32 v24, v52, v52
    v_fma_f32 v24, v24, s60, v29
    v_mul_f32 v24, v24, v52
    v_exp_f32 v25, v24
    s_nop 0
    v_add_f32 v25, 1.0, v25
    v_rcp_f32 v25, v25
    s_nop 0
    v_mul_f32 v52, v52, v25
    v_cvt_pk_bf16_f32 v53, v53, v53
    v_and_b32 v53, 0xffff0000, v53
    v_add_f32 v53, v53, v13
    v_cvt_pk_bf16_f32 v53, v53, v53
    v_and_b32 v53, 0xffff0000, v53
    v_mul_f32 v24, v53, v53
    v_fma_f32 v24, v24, s60, v29
    v_mul_f32 v24, v24, v53
    v_exp_f32 v25, v24
    s_nop 0
    v_add_f32 v25, 1.0, v25
    v_rcp_f32 v25, v25
    s_nop 0
    v_mul_f32 v53, v53, v25
    v_cvt_pk_bf16_f32 v54, v54, v54
    v_and_b32 v54, 0xffff0000, v54
    v_add_f32 v54, v54, v14
    v_cvt_pk_bf16_f32 v54, v54, v54
    v_and_b32 v54, 0xffff0000, v54
    v_mul_f32 v24, v54, v54
    v_fma_f32 v24, v24, s60, v29
    v_mul_f32 v24, v24, v54
    v_exp_f32 v25, v24
    s_nop 0
    v_add_f32 v25, 1.0, v25
    v_rcp_f32 v25, v25
    s_nop 0
    v_mul_f32 v54, v54, v25
    v_cvt_pk_bf16_f32 v55, v55, v55
    v_and_b32 v55, 0xffff0000, v55
    v_add_f32 v55, v55, v15
    v_cvt_pk_bf16_f32 v55, v55, v55
    v_and_b32 v55, 0xffff0000, v55
    v_mul_f32 v24, v55, v55
    v_fma_f32 v24, v24, s60, v29
    v_mul_f32 v24, v24, v55
    v_exp_f32 v25, v24
    s_nop 0
    v_add_f32 v25, 1.0, v25
    v_rcp_f32 v25, v25
    s_nop 0
    v_mul_f32 v55, v55, v25
    v_cvt_pk_bf16_f32 v48, v48, v49
    v_min_u32 v48, -2, v48
    v_cvt_pk_bf16_f32 v49, v50, v51
    v_min_u32 v49, -2, v49
    v_cvt_pk_bf16_f32 v50, v52, v53
    v_min_u32 v50, -2, v50
    v_cvt_pk_bf16_f32 v51, v54, v55
    v_min_u32 v51, -2, v51
    v_and_b32 v24, 1, v1
    v_lshlrev_b32 v24, 2, v24
    v_and_b32 v25, 2, v1
    v_add_u32 v24, v24, v25
    v_mul_u32_u24 v24, 9216, v24
    v_lshl_add_u32 v24, v2, 3, v24
    s_mov_b32 s74, 0x40000
    s_load_dword s60, s[30:31], 0
L_mark1_poll:
    s_waitcnt lgkmcnt(0)
    s_cmp_ge_u32 s60, 64
    s_cbranch_scc1 L_mark1_go
    s_sleep 64
    s_mov_b32 s60, 0
    s_atomic_add s60, s[30:31], 0 glc
    s_sub_u32 s74, s74, 1
    s_cmp_lg_u32 s74, 0
    s_cbranch_scc1 L_mark1_poll
    s_waitcnt lgkmcnt(0)
L_mark1_go:
    s_add_u32 s58, s54, 737280
    s_add_u32 s59, s54, 746496
    buffer_store_dwordx2 v[48:49], v24, s[48:51], s58 offen sc1
    buffer_store_dwordx2 v[50:51], v24, s[48:51], s59 offen sc1
L_nog1:
    s_mul_i32 s58, s35, 147456
    s_add_u32 s40, s16, s58
    s_addc_u32 s41, s17, 0
    s_and_b32 s41, s41, 0xffff
    s_mov_b32 s42, 147456
    s_mov_b32 s43, 0x20000
    v_mul_u32_u24 v4, 9216, v1
    s_lshl_b32 s59, s4, 8
    v_lshl_add_u32 v3, v2, 4, v4
    v_add_u32 v3, s59, v3
    s_lshl_b32 s59, s4, 5
    s_add_u32 s59, s59, 1024
    v_lshl_add_u32 v4, v2, 1, v4
    v_add_u32 v4, s59, v4
    s_add_u32 s56, s34, 0
    s_and_b32 s56, s56, 6
    s_lshl_b32 s56, s56, 2
    s_and_b32 s59, s34, 1
    s_xor_b32 s59, s59, 0
    s_add_u32 s56, s56, s59
    s_mul_i32 s56, s56, 4608
    buffer_load_dwordx4 v[64:67], v3, s[40:43], s56 offen offset:0
    buffer_load_ushort v96, v4, s[40:43], s56 offen offset:0
    s_waitcnt vmcnt(0)
    buffer_load_dwordx4 v[68:71], v3, s[40:43], s56 offen offset:1152
    buffer_load_ushort v97, v4, s[40:43], s56 offen offset:1152
    s_waitcnt vmcnt(0)
    buffer_load_dwordx4 v[72:75], v3, s[40:43], s56 offen offset:2304
    buffer_load_ushort v98, v4, s[40:43], s56 offen offset:2304
    s_waitcnt vmcnt(0)
    buffer_load_dwordx4 v[76:79], v3, s[40:43], s56 offen offset:3456
    buffer_load_ushort v99, v4, s[40:43], s56 offen offset:3456
    s_add_u32 s56, s34, 0
    s_and_b32 s56, s56, 6
    s_lshl_b32 s56, s56, 2
    s_and_b32 s59, s34, 1
    s_xor_b32 s59, s59, 1
    s_add_u32 s56, s56, s59
    s_mul_i32 s56, s56, 4608
    s_waitcnt vmcnt(0)
    buffer_load_dwordx4 v[80:83], v3, s[40:43], s56 offen offset:0
    buffer_load_ushort v100, v4, s[40:43], s56 offen offset:0
    s_waitcnt vmcnt(0)
    buffer_load_dwordx4 v[84:87], v3, s[40:43], s56 offen offset:1152
    buffer_load_ushort v101, v4, s[40:43], s56 offen offset:1152
    s_waitcnt vmcnt(0)
    buffer_load_dwordx4 v[88:91], v3, s[40:43], s56 offen offset:2304
    buffer_load_ushort v102, v4, s[40:43], s56 offen offset:2304
    s_waitcnt vmcnt(0)
    buffer_load_dwordx4 v[92:95], v3, s[40:43], s56 offen offset:3456
    buffer_load_ushort v103, v4, s[40:43], s56 offen offset:3456
    s_waitcnt vmcnt(0)
    v_perm_b32 v112, v68, v64, s66
    v_perm_b32 v120, v68, v64, s67
    v_perm_b32 v113, v76, v72, s66
    v_perm_b32 v121, v76, v72, s67
    v_perm_b32 v114, v84, v80, s66
    v_perm_b32 v122, v84, v80, s67
    v_perm_b32 v115, v92, v88, s66
    v_perm_b32 v123, v92, v88, s67
    v_perm_b32 v128, v69, v65, s66
    v_perm_b32 v136, v69, v65, s67
    v_perm_b32 v129, v77, v73, s66
    v_perm_b32 v137, v77, v73, s67
    v_perm_b32 v130, v85, v81, s66
    v_perm_b32 v138, v85, v81, s67
    v_perm_b32 v131, v93, v89, s66
    v_perm_b32 v139, v93, v89, s67
    v_perm_b32 v144, v70, v66, s66
    v_perm_b32 v152, v70, v66, s67
    v_perm_b32 v145, v78, v74, s66
    v_perm_b32 v153, v78, v74, s67
    v_perm_b32 v146, v86, v82, s66
    v_perm_b32 v154, v86, v82, s67
    v_perm_b32 v147, v94, v90, s66
    v_perm_b32 v155, v94, v90, s67
    v_perm_b32 v160, v71, v67, s66
    v_perm_b32 v168, v71, v67, s67
    v_perm_b32 v161, v79, v75, s66
    v_perm_b32 v169, v79, v75, s67
    v_perm_b32 v162, v87, v83, s66
    v_perm_b32 v170, v87, v83, s67
    v_perm_b32 v163, v95, v91, s66
    v_perm_b32 v171, v95, v91, s67
    v_perm_b32 v176, v97, v96, s66
    v_perm_b32 v177, v99, v98, s66
    v_perm_b32 v178, v101, v100, s66
    v_perm_b32 v179, v103, v102, s66
    s_add_u32 s56, s34, 2
    s_and_b32 s56, s56, 6
    s_lshl_b32 s56, s56, 2
    s_and_b32 s59, s34, 1
    s_xor_b32 s59, s59, 0
    s_add_u32 s56, s56, s59
    s_mul_i32 s56, s56, 4608
    buffer_load_dwordx4 v[64:67], v3, s[40:43], s56 offen offset:0
    buffer_load_ushort v96, v4, s[40:43], s56 offen offset:0
    s_waitcnt vmcnt(0)
    buffer_load_dwordx4 v[68:71], v3, s[40:43], s56 offen offset:1152
    buffer_load_ushort v97, v4, s[40:43], s56 offen offset:1152
    s_waitcnt vmcnt(0)
    buffer_load_dwordx4 v[72:75], v3, s[40:43], s56 offen offset:2304
    buffer_load_ushort v98, v4, s[40:43], s56 offen offset:2304
    s_waitcnt vmcnt(0)
    buffer_load_dwordx4 v[76:79], v3, s[40:43], s56 offen offset:3456
    buffer_load_ushort v99, v4, s[40:43], s56 offen offset:3456
    s_add_u32 s56, s34, 2
    s_and_b32 s56, s56, 6
    s_lshl_b32 s56, s56, 2
    s_and_b32 s59, s34, 1
    s_xor_b32 s59, s59, 1
    s_add_u32 s56, s56, s59
    s_mul_i32 s56, s56, 4608
    s_waitcnt vmcnt(0)
    buffer_load_dwordx4 v[80:83], v3, s[40:43], s56 offen offset:0
    buffer_load_ushort v100, v4, s[40:43], s56 offen offset:0
    s_waitcnt vmcnt(0)
    buffer_load_dwordx4 v[84:87], v3, s[40:43], s56 offen offset:1152
    buffer_load_ushort v101, v4, s[40:43], s56 offen offset:1152
    s_waitcnt vmcnt(0)
    buffer_load_dwordx4 v[88:91], v3, s[40:43], s56 offen offset:2304
    buffer_load_ushort v102, v4, s[40:43], s56 offen offset:2304
    s_waitcnt vmcnt(0)
    buffer_load_dwordx4 v[92:95], v3, s[40:43], s56 offen offset:3456
    buffer_load_ushort v103, v4, s[40:43], s56 offen offset:3456
    s_waitcnt vmcnt(0)
    v_perm_b32 v116, v68, v64, s66
    v_perm_b32 v124, v68, v64, s67
    v_perm_b32 v117, v76, v72, s66
    v_perm_b32 v125, v76, v72, s67
    v_perm_b32 v118, v84, v80, s66
    v_perm_b32 v126, v84, v80, s67
    v_perm_b32 v119, v92, v88, s66
    v_perm_b32 v127, v92, v88, s67
    v_perm_b32 v132, v69, v65, s66
    v_perm_b32 v140, v69, v65, s67
    v_perm_b32 v133, v77, v73, s66
    v_perm_b32 v141, v77, v73, s67
    v_perm_b32 v134, v85, v81, s66
    v_perm_b32 v142, v85, v81, s67
    v_perm_b32 v135, v93, v89, s66
    v_perm_b32 v143, v93, v89, s67
    v_perm_b32 v148, v70, v66, s66
    v_perm_b32 v156, v70, v66, s67
    v_perm_b32 v149, v78, v74, s66
    v_perm_b32 v157, v78, v74, s67
    v_perm_b32 v150, v86, v82, s66
    v_perm_b32 v158, v86, v82, s67
    v_perm_b32 v151, v94, v90, s66
    v_perm_b32 v159, v94, v90, s67
    v_perm_b32 v164, v71, v67, s66
    v_perm_b32 v172, v71, v67, s67
    v_perm_b32 v165, v79, v75, s66
    v_perm_b32 v173, v79, v75, s67
    v_perm_b32 v166, v87, v83, s66
    v_perm_b32 v174, v87, v83, s67
    v_perm_b32 v167, v95, v91, s66
    v_perm_b32 v175, v95, v91, s67
    v_perm_b32 v180, v97, v96, s66
    v_perm_b32 v181, v99, v98, s66
    v_perm_b32 v182, v101, v100, s66
    v_perm_b32 v183, v103, v102, s66
    s_cmp_lg_u32 s4, 2
    s_cbranch_scc1 L_nofb24
    s_mov_b32 s74, 0x40000
    s_load_dword s60, s[30:31], 0
L_markb24_poll:
    s_waitcnt lgkmcnt(0)
    s_cmp_ge_u32 s60, 64
    s_cbranch_scc1 L_markb24_go
    s_sleep 64
    s_mov_b32 s60, 0
    s_atomic_add s60, s[30:31], 0 glc
    s_sub_u32 s74, s74, 1
    s_cmp_lg_u32 s74, 0
    s_cbranch_scc1 L_markb24_poll
    s_waitcnt lgkmcnt(0)
L_markb24_go:
    v_mov_b32 v26, 0
    v_lshlrev_b32 v28, 24, v0
    s_and_b32 s58, s2, 7
    s_mul_i32 s54, s58, 24
    s_add_u32 s54, s54, s2
    s_and_b32 s54, s54, 0xff
    s_lshr_b32 s56, s54, 6
    s_mul_i32 s56, s56, 2048
    s_add_u32 s56, s56, 811008
    s_and_b32 s54, s54, 63
    s_add_u32 s36, s32, s56
    s_addc_u32 s37, s33, 0
L_fba1:
    s_sleep 1
    ds_read_b32 v24, v26 offset:3364
    s_waitcnt lgkmcnt(0)
    v_readfirstlane_b32 s58, v24
    s_cmp_lt_u32 s58, 122
    s_cbranch_scc1 L_fba1
    s_load_dword s80, s[36:37], 0 glc
    s_load_dword s81, s[36:37], 128 glc
    s_load_dword s82, s[36:37], 256 glc
    s_load_dword s83, s[36:37], 384 glc
    s_load_dword s84, s[36:37], 512 glc
    s_load_dword s85, s[36:37], 640 glc
    s_load_dword s86, s[36:37], 768 glc
    s_load_dword s87, s[36:37], 896 glc
    s_load_dword s88, s[36:37], 1024 glc
    s_load_dword s89, s[36:37], 1152 glc
    s_load_dword s90, s[36:37], 1280 glc
    s_load_dword s91, s[36:37], 1408 glc
    s_load_dword s92, s[36:37], 1536 glc
    s_load_dword s93, s[36:37], 1664 glc
    s_load_dword s94, s[36:37], 1792 glc
    s_load_dword s95, s[36:37], 1920 glc
    s_mov_b32 s58, 16
    s_waitcnt lgkmcnt(0)
    s_add_u32 s58, s58, s80
    s_add_u32 s58, s58, s81
    s_add_u32 s58, s58, s82
    s_add_u32 s58, s58, s83
    s_add_u32 s58, s58, s84
    s_add_u32 s58, s58, s85
    s_add_u32 s58, s58, s86
    s_add_u32 s58, s58, s87
    s_add_u32 s58, s58, s88
    s_add_u32 s58, s58, s89
    s_add_u32 s58, s58, s90
    s_add_u32 s58, s58, s91
    s_add_u32 s58, s58, s92
    s_add_u32 s58, s58, s93
    s_add_u32 s58, s58, s94
    s_add_u32 s58, s58, s95
    s_mov_b32 s60, s58
    s_mul_i32 s58, s58, 5
    s_ashr_i32 s58, s58, 2
    s_add_i32 s58, s58, 1
    s_cmp_eq_u32 s60, 0
    s_cselect_b32 s58, 0, s58
    s_max_i32 s58, s58, 0
    s_add_i32 s58, s58, s52
    s_min_i32 s58, s58, 32
    v_mov_b32 v25, s58
    ds_write_b32 v26, v25 offset:3368
    s_cmp_ge_u32 s60, 99
    s_cbranch_scc1 L_fbc1
    s_cmp_ge_u32 s54, 16
    s_cbranch_scc1 L_fbc1
    s_lshl_b32 s54, s54, 7
    s_add_u32 s54, s54, s56
L_fbb1:
    s_sleep 1
    ds_read_b32 v24, v26 offset:3364
    s_waitcnt lgkmcnt(0)
    v_readfirstlane_b32 s58, v24
    s_cmp_lt_u32 s58, 130
    s_cbranch_scc1 L_fbb1
    buffer_store_dword v26, v28, s[48:51], s54 offen sc1
L_fbc1:
L_nofb24:
    s_add_u32 s56, s34, 4
    s_and_b32 s56, s56, 6
    s_lshl_b32 s56, s56, 2
    s_and_b32 s59, s34, 1
    s_xor_b32 s59, s59, 0
    s_add_u32 s56, s56, s59
    s_mul_i32 s56, s56, 4608
    buffer_load_dwordx4 v[64:67], v3, s[40:43], s56 offen offset:0
    buffer_load_ushort v96, v4, s[40:43], s56 offen offset:0
    s_waitcnt vmcnt(0)
    buffer_load_dwordx4 v[68:71], v3, s[40:43], s56 offen offset:1152
    buffer_load_ushort v97, v4, s[40:43], s56 offen offset:1152
    s_waitcnt vmcnt(0)
    buffer_load_dwordx4 v[72:75], v3, s[40:43], s56 offen offset:2304
    buffer_load_ushort v98, v4, s[40:43], s56 offen offset:2304
    s_waitcnt vmcnt(0)
    buffer_load_dwordx4 v[76:79], v3, s[40:43], s56 offen offset:3456
    buffer_load_ushort v99, v4, s[40:43], s56 offen offset:3456
    s_add_u32 s56, s34, 4
    s_and_b32 s56, s56, 6
    s_lshl_b32 s56, s56, 2
    s_and_b32 s59, s34, 1
    s_xor_b32 s59, s59, 1
    s_add_u32 s56, s56, s59
    s_mul_i32 s56, s56, 4608
    s_waitcnt vmcnt(0)
    buffer_load_dwordx4 v[80:83], v3, s[40:43], s56 offen offset:0
    buffer_load_ushort v100, v4, s[40:43], s56 offen offset:0
    s_waitcnt vmcnt(0)
    buffer_load_dwordx4 v[84:87], v3, s[40:43], s56 offen offset:1152
    buffer_load_ushort v101, v4, s[40:43], s56 offen offset:1152
    s_waitcnt vmcnt(0)
    buffer_load_dwordx4 v[88:91], v3, s[40:43], s56 offen offset:2304
    buffer_load_ushort v102, v4, s[40:43], s56 offen offset:2304
    s_waitcnt vmcnt(0)
    buffer_load_dwordx4 v[92:95], v3, s[40:43], s56 offen offset:3456
    buffer_load_ushort v103, v4, s[40:43], s56 offen offset:3456
    s_waitcnt vmcnt(0)
    v_perm_b32 v184, v68, v64, s66
    v_perm_b32 v192, v68, v64, s67
    v_perm_b32 v185, v76, v72, s66
    v_perm_b32 v193, v76, v72, s67
    v_perm_b32 v186, v84, v80, s66
    v_perm_b32 v194, v84, v80, s67
    v_perm_b32 v187, v92, v88, s66
    v_perm_b32 v195, v92, v88, s67
    v_perm_b32 v200, v69, v65, s66
    v_perm_b32 v208, v69, v65, s67
    v_perm_b32 v201, v77, v73, s66
    v_perm_b32 v209, v77, v73, s67
    v_perm_b32 v202, v85, v81, s66
    v_perm_b32 v210, v85, v81, s67
    v_perm_b32 v203, v93, v89, s66
    v_perm_b32 v211, v93, v89, s67
    v_perm_b32 v216, v70, v66, s66
    v_perm_b32 v224, v70, v66, s67
    v_perm_b32 v217, v78, v74, s66
    v_perm_b32 v225, v78, v74, s67
    v_perm_b32 v218, v86, v82, s66
    v_perm_b32 v226, v86, v82, s67
    v_perm_b32 v219, v94, v90, s66
    v_perm_b32 v227, v94, v90, s67
    v_perm_b32 v232, v71, v67, s66
    v_perm_b32 v240, v71, v67, s67
    v_perm_b32 v233, v79, v75, s66
    v_perm_b32 v241, v79, v75, s67
    v_perm_b32 v234, v87, v83, s66
    v_perm_b32 v242, v87, v83, s67
    v_perm_b32 v235, v95, v91, s66
    v_perm_b32 v243, v95, v91, s67
    v_perm_b32 v248, v97, v96, s66
    v_perm_b32 v249, v99, v98, s66
    v_perm_b32 v250, v101, v100, s66
    v_perm_b32 v251, v103, v102, s66
    s_add_u32 s56, s34, 6
    s_and_b32 s56, s56, 6
    s_lshl_b32 s56, s56, 2
    s_and_b32 s59, s34, 1
    s_xor_b32 s59, s59, 0
    s_add_u32 s56, s56, s59
    s_mul_i32 s56, s56, 4608
    buffer_load_dwordx4 v[64:67], v3, s[40:43], s56 offen offset:0
    buffer_load_ushort v96, v4, s[40:43], s56 offen offset:0
    s_waitcnt vmcnt(0)
    buffer_load_dwordx4 v[68:71], v3, s[40:43], s56 offen offset:1152
    buffer_load_ushort v97, v4, s[40:43], s56 offen offset:1152
    s_waitcnt vmcnt(0)
    buffer_load_dwordx4 v[72:75], v3, s[40:43], s56 offen offset:2304
    buffer_load_ushort v98, v4, s[40:43], s56 offen offset:2304
    s_waitcnt vmcnt(0)
    buffer_load_dwordx4 v[76:79], v3, s[40:43], s56 offen offset:3456
    buffer_load_ushort v99, v4, s[40:43], s56 offen offset:3456
    s_add_u32 s56, s34, 6
    s_and_b32 s56, s56, 6
    s_lshl_b32 s56, s56, 2
    s_and_b32 s59, s34, 1
    s_xor_b32 s59, s59, 1
    s_add_u32 s56, s56, s59
    s_mul_i32 s56, s56, 4608
    s_waitcnt vmcnt(0)
    buffer_load_dwordx4 v[80:83], v3, s[40:43], s56 offen offset:0
    buffer_load_ushort v100, v4, s[40:43], s56 offen offset:0
    s_waitcnt vmcnt(0)
    buffer_load_dwordx4 v[84:87], v3, s[40:43], s56 offen offset:1152
    buffer_load_ushort v101, v4, s[40:43], s56 offen offset:1152
    s_waitcnt vmcnt(0)
    buffer_load_dwordx4 v[88:91], v3, s[40:43], s56 offen offset:2304
    buffer_load_ushort v102, v4, s[40:43], s56 offen offset:2304
    s_waitcnt vmcnt(0)
    buffer_load_dwordx4 v[92:95], v3, s[40:43], s56 offen offset:3456
    buffer_load_ushort v103, v4, s[40:43], s56 offen offset:3456
    s_waitcnt vmcnt(0)
    v_perm_b32 v188, v68, v64, s66
    v_perm_b32 v196, v68, v64, s67
    v_perm_b32 v189, v76, v72, s66
    v_perm_b32 v197, v76, v72, s67
    v_perm_b32 v190, v84, v80, s66
    v_perm_b32 v198, v84, v80, s67
    v_perm_b32 v191, v92, v88, s66
    v_perm_b32 v199, v92, v88, s67
    v_perm_b32 v204, v69, v65, s66
    v_perm_b32 v212, v69, v65, s67
    v_perm_b32 v205, v77, v73, s66
    v_perm_b32 v213, v77, v73, s67
    v_perm_b32 v206, v85, v81, s66
    v_perm_b32 v214, v85, v81, s67
    v_perm_b32 v207, v93, v89, s66
    v_perm_b32 v215, v93, v89, s67
    v_perm_b32 v220, v70, v66, s66
    v_perm_b32 v228, v70, v66, s67
    v_perm_b32 v221, v78, v74, s66
    v_perm_b32 v229, v78, v74, s67
    v_perm_b32 v222, v86, v82, s66
    v_perm_b32 v230, v86, v82, s67
    v_perm_b32 v223, v94, v90, s66
    v_perm_b32 v231, v94, v90, s67
    v_perm_b32 v236, v71, v67, s66
    v_perm_b32 v244, v71, v67, s67
    v_perm_b32 v237, v79, v75, s66
    v_perm_b32 v245, v79, v75, s67
    v_perm_b32 v238, v87, v83, s66
    v_perm_b32 v246, v87, v83, s67
    v_perm_b32 v239, v95, v91, s66
    v_perm_b32 v247, v95, v91, s67
    v_perm_b32 v252, v97, v96, s66
    v_perm_b32 v253, v99, v98, s66
    v_perm_b32 v254, v101, v100, s66
    v_perm_b32 v255, v103, v102, s66
    s_mov_b32 s74, 0x40000
    s_load_dword s60, s[30:31], 0
L_mark_poll:
    s_waitcnt lgkmcnt(0)
    s_cmp_ge_u32 s60, 64
    s_cbranch_scc1 L_mark_go
    s_sleep 64
    s_mov_b32 s60, 0
    s_atomic_add s60, s[30:31], 0 glc
    s_sub_u32 s74, s74, 1
    s_cmp_lg_u32 s74, 0
    s_cbranch_scc1 L_mark_poll
    s_waitcnt lgkmcnt(0)
L_mark_go:
    v_mov_b32 v13, 0x1000000
    s_cmp_lg_u32 s4, 3
    s_cbranch_scc1 L_nog2
    s_lshr_b32 s54, s2, 3
    s_sub_u32 s54, s54, 23
    s_cmp_ge_u32 s54, 9
    s_cbranch_scc1 L_nog2
    s_and_b32 s55, s2, 7
    v_lshrrev_b32 v24, 3, v0
    v_and_b32 v25, 7, v0
    v_lshlrev_b32 v25, 4, v25
    v_mul_u32_u24 v3, 9216, v24
    v_add_u32 v3, v3, v25
    v_mul_u32_u24 v4, 1168, v24
    v_add_u32 v4, v4, v25
    s_mul_i32 s58, s55, 1152
    s_add_u32 s58, s58, 737280
    s_mov_b32 s74, 65536
L_h_poll:
    buffer_load_dwordx4 v[64:67], v3, s[48:51], s58 offen offset:0 sc1
    buffer_load_dwordx4 v[68:71], v3, s[48:51], s58 offen offset:128 sc1
    buffer_load_dwordx4 v[72:75], v3, s[48:51], s58 offen offset:256 sc1
    buffer_load_dwordx4 v[76:79], v3, s[48:51], s58 offen offset:384 sc1
    buffer_load_dwordx4 v[80:83], v3, s[48:51], s58 offen offset:512 sc1
    buffer_load_dwordx4 v[84:87], v3, s[48:51], s58 offen offset:640 sc1
    buffer_load_dwordx4 v[88:91], v3, s[48:51], s58 offen offset:768 sc1
    buffer_load_dwordx4 v[92:95], v3, s[48:51], s58 offen offset:896 sc1
    buffer_load_dwordx4 v[96:99], v3, s[48:51], s58 offen offset:1024 sc1
    s_waitcnt vmcnt(0)
    v_max_u32 v24, v64, v65
    v_max3_u32 v24, v24, v66, v67
    v_max3_u32 v24, v24, v68, v69
    v_max3_u32 v24, v24, v70, v71
    v_max3_u32 v24, v24, v72, v73
    v_max3_u32 v24, v24, v74, v75
    v_max3_u32 v24, v24, v76, v77
    v_max3_u32 v24, v24, v78, v79
    v_max3_u32 v24, v24, v80, v81
    v_max3_u32 v24, v24, v82, v83
    v_max3_u32 v24, v24, v84, v85
    v_max3_u32 v24, v24, v86, v87
    v_max3_u32 v24, v24, v88, v89
    v_max3_u32 v24, v24, v90, v91
    v_max3_u32 v24, v24, v92, v93
    v_max3_u32 v24, v24, v94, v95
    v_max3_u32 v24, v24, v96, v97
    v_max3_u32 v24, v24, v98, v99
    v_cmp_eq_u32 vcc, -1, v24
    s_sub_u32 s74, s74, 1
    s_cbranch_vccz L_h_go
    s_sleep 64
    s_cmp_lg_u32 s74, 0
    s_cbranch_scc1 L_h_poll
L_h_go:
    ds_write_b128 v4, v[64:67] offset:4096
    ds_write_b128 v4, v[68:71] offset:4224
    ds_write_b128 v4, v[72:75] offset:4352
    ds_write_b128 v4, v[76:79] offset:4480
    ds_write_b128 v4, v[80:83] offset:4608
    ds_write_b128 v4, v[84:87] offset:4736
    ds_write_b128 v4, v[88:91] offset:4864
    ds_write_b128 v4, v[92:95] offset:4992
    ds_write_b128 v4, v[96:99] offset:5120
    s_lshl_b32 s54, s54, 7
    s_mul_i32 s58, s55, 663552
    s_add_u32 s58, s58, s54
    s_add_u32 s36, s24, s58
    s_addc_u32 s37, s25, 0
    s_and_b32 s37, s37, 0xffff
    s_mov_b32 s38, 0
    s_mov_b32 s39, 0x20000
    s_sub_u32 s38, 663552, s54
    v_mul_u32_u24 v3, 9216, v1
    v_lshl_add_u32 v3, v2, 3, v3
    v_and_b32 v4, 7, v0
    v_mul_u32_u24 v4, 1168, v4
    v_lshl_add_u32 v4, v1, 4, v4
    v_mov_b32 v32, 0
    v_mov_b32 v33, 0
    v_mov_b32 v34, 0
    v_mov_b32 v35, 0
    v_mov_b32 v36, 0
    v_mov_b32 v37, 0
    v_mov_b32 v38, 0
    v_mov_b32 v39, 0
    v_mov_b32 v40, 0
    v_mov_b32 v41, 0
    v_mov_b32 v42, 0
    v_mov_b32 v43, 0
    v_mov_b32 v44, 0
    v_mov_b32 v45, 0
    v_mov_b32 v46, 0
    v_mov_b32 v47, 0
    s_waitcnt lgkmcnt(0)
    s_mov_b32 s56, 0
    s_waitcnt vmcnt(7)
    buffer_load_dwordx2 v[64:65], v3, s[36:39], s56 offen nt
    s_add_u32 s56, s56, 1152
    s_waitcnt vmcnt(7)
    buffer_load_dwordx2 v[66:67], v3, s[36:39], s56 offen nt
    s_add_u32 s56, s56, 1152
    s_waitcnt vmcnt(7)
    buffer_load_dwordx2 v[68:69], v3, s[36:39], s56 offen nt
    s_add_u32 s56, s56, 1152
    s_waitcnt vmcnt(7)
    buffer_load_dwordx2 v[70:71], v3, s[36:39], s56 offen nt
    s_add_u32 s56, s56, 1152
    s_waitcnt vmcnt(7)
    buffer_load_dwordx2 v[72:73], v3, s[36:39], s56 offen nt
    s_add_u32 s56, s56, 1152
    s_waitcnt vmcnt(7)
    buffer_load_dwordx2 v[74:75], v3, s[36:39], s56 offen nt
    s_add_u32 s56, s56, 1152
    s_waitcnt vmcnt(7)
    buffer_load_dwordx2 v[76:77], v3, s[36:39], s56 offen nt
    s_add_u32 s56, s56, 1152
    s_waitcnt vmcnt(7)
    buffer_load_dwordx2 v[78:79], v3, s[36:39], s56 offen nt
    s_add_u32 s56, s56, 28800
    s_mov_b32 s57, 9
L_g2:
    s_waitcnt vmcnt(7)
    buffer_load_dwordx2 v[80:81], v3, s[36:39], s56 offen nt
    s_add_u32 s56, s56, 1152
    s_waitcnt vmcnt(7)
    buffer_load_dwordx2 v[82:83], v3, s[36:39], s56 offen nt
    s_add_u32 s56, s56, 1152
    s_waitcnt vmcnt(7)
    buffer_load_dwordx2 v[84:85], v3, s[36:39], s56 offen nt
    s_add_u32 s56, s56, 1152
    s_waitcnt vmcnt(7)
    buffer_load_dwordx2 v[86:87], v3, s[36:39], s56 offen nt
    s_add_u32 s56, s56, 1152
    s_waitcnt vmcnt(7)
    buffer_load_dwordx2 v[88:89], v3, s[36:39], s56 offen nt
    s_add_u32 s56, s56, 1152
    s_waitcnt vmcnt(7)
    buffer_load_dwordx2 v[90:91], v3, s[36:39], s56 offen nt
    s_add_u32 s56, s56, 1152
    s_waitcnt vmcnt(7)
    buffer_load_dwordx2 v[92:93], v3, s[36:39], s56 offen nt
    s_add_u32 s56, s56, 1152
    s_waitcnt vmcnt(7)
    buffer_load_dwordx2 v[94:95], v3, s[36:39], s56 offen nt
    s_add_u32 s56, s56, 28800
    ds_read_b128 v[56:59], v4 offset:4096
    s_waitcnt vmcnt(8)
    v_perm_b32 v96, v66, v64, s66
    v_perm_b32 v100, v66, v64, s67
    v_perm_b32 v97, v70, v68, s66
    v_perm_b32 v101, v70, v68, s67
    v_perm_b32 v98, v74, v72, s66
    v_perm_b32 v102, v74, v72, s67
    v_perm_b32 v99, v78, v76, s66
    v_perm_b32 v103, v78, v76, s67
    v_perm_b32 v104, v67, v65, s66
    v_perm_b32 v108, v67, v65, s67
    v_perm_b32 v105, v71, v69, s66
    v_perm_b32 v109, v71, v69, s67
    v_perm_b32 v106, v75, v73, s66
    v_perm_b32 v110, v75, v73, s67
    v_perm_b32 v107, v79, v77, s66
    v_perm_b32 v111, v79, v77, s67
    s_waitcnt lgkmcnt(0)
    s_nop 0
    v_mfma_f32_16x16x32_bf16 v[32:35], v[56:59], v[96:99], v[32:35]
    v_mfma_f32_16x16x32_bf16 v[36:39], v[56:59], v[100:103], v[36:39]
    v_mfma_f32_16x16x32_bf16 v[40:43], v[56:59], v[104:107], v[40:43]
    v_mfma_f32_16x16x32_bf16 v[44:47], v[56:59], v[108:111], v[44:47]
    s_waitcnt vmcnt(7)
    buffer_load_dwordx2 v[64:65], v3, s[36:39], s56 offen nt
    s_add_u32 s56, s56, 1152
    s_waitcnt vmcnt(7)
    buffer_load_dwordx2 v[66:67], v3, s[36:39], s56 offen nt
    s_add_u32 s56, s56, 1152
    s_waitcnt vmcnt(7)
    buffer_load_dwordx2 v[68:69], v3, s[36:39], s56 offen nt
    s_add_u32 s56, s56, 1152
    s_waitcnt vmcnt(7)
    buffer_load_dwordx2 v[70:71], v3, s[36:39], s56 offen nt
    s_add_u32 s56, s56, 1152
    s_waitcnt vmcnt(7)
    buffer_load_dwordx2 v[72:73], v3, s[36:39], s56 offen nt
    s_add_u32 s56, s56, 1152
    s_waitcnt vmcnt(7)
    buffer_load_dwordx2 v[74:75], v3, s[36:39], s56 offen nt
    s_add_u32 s56, s56, 1152
    s_waitcnt vmcnt(7)
    buffer_load_dwordx2 v[76:77], v3, s[36:39], s56 offen nt
    s_add_u32 s56, s56, 1152
    s_waitcnt vmcnt(7)
    buffer_load_dwordx2 v[78:79], v3, s[36:39], s56 offen nt
    s_add_u32 s56, s56, 28800
    ds_read_b128 v[56:59], v4 offset:4160
    s_waitcnt vmcnt(8)
    v_perm_b32 v96, v82, v80, s66
    v_perm_b32 v100, v82, v80, s67
    v_perm_b32 v97, v86, v84, s66
    v_perm_b32 v101, v86, v84, s67
    v_perm_b32 v98, v90, v88, s66
    v_perm_b32 v102, v90, v88, s67
    v_perm_b32 v99, v94, v92, s66
    v_perm_b32 v103, v94, v92, s67
    v_perm_b32 v104, v83, v81, s66
    v_perm_b32 v108, v83, v81, s67
    v_perm_b32 v105, v87, v85, s66
    v_perm_b32 v109, v87, v85, s67
    v_perm_b32 v106, v91, v89, s66
    v_perm_b32 v110, v91, v89, s67
    v_perm_b32 v107, v95, v93, s66
    v_perm_b32 v111, v95, v93, s67
    s_waitcnt lgkmcnt(0)
    s_nop 0
    v_mfma_f32_16x16x32_bf16 v[32:35], v[56:59], v[96:99], v[32:35]
    v_mfma_f32_16x16x32_bf16 v[36:39], v[56:59], v[100:103], v[36:39]
    v_mfma_f32_16x16x32_bf16 v[40:43], v[56:59], v[104:107], v[40:43]
    v_mfma_f32_16x16x32_bf16 v[44:47], v[56:59], v[108:111], v[44:47]
    v_add_u32 v4, 128, v4
    s_sub_u32 s57, s57, 1
    s_cmp_lg_u32 s57, 0
    s_cbranch_scc1 L_g2
    s_waitcnt vmcnt(0)
    s_nop 3
    v_cndmask_b32 v48, v32, v34, s[70:71]
    v_cndmask_b32 v49, v36, v38, s[70:71]
    v_cndmask_b32 v50, v40, v42, s[70:71]
    v_cndmask_b32 v51, v44, v46, s[70:71]
    v_cndmask_b32 v52, v33, v35, s[70:71]
    v_cndmask_b32 v53, v37, v39, s[70:71]
    v_cndmask_b32 v54, v41, v43, s[70:71]
    v_cndmask_b32 v55, v45, v47, s[70:71]
    v_min_u32 v48, -2, v48
    v_min_u32 v49, -2, v49
    v_min_u32 v50, -2, v50
    v_min_u32 v51, -2, v51
    v_min_u32 v52, -2, v52
    v_min_u32 v53, -2, v53
    v_min_u32 v54, -2, v54
    v_min_u32 v55, -2, v55
    v_and_b32 v24, 1, v1
    v_lshlrev_b32 v24, 2, v24
    v_and_b32 v25, 2, v1
    v_add_u32 v24, v24, v25
    v_mul_u32_u24 v24, 2304, v24
    v_lshl_add_u32 v24, v2, 4, v24
    s_mul_i32 s58, s55, 18432
    s_lshl_b32 s54, s54, 1
    s_add_u32 s58, s58, s54
    s_add_u32 s58, s58, 589824
    v_mov_b32 v96, v48
    v_mov_b32 v97, v49
    v_mov_b32 v98, v50
    v_mov_b32 v99, v51
    v_mov_b32 v100, v52
    v_mov_b32 v101, v53
    v_mov_b32 v102, v54
    v_mov_b32 v103, v55
    v_add_u32 v13, s58, v24
L_nog2:
    s_lshl_b32 s59, s4, 2
    v_mov_b32 v27, s59
    s_lshl_b32 s59, s4, 15
    s_add_u32 s59, s59, 16384
    v_lshlrev_b32 v25, 4, v0
    v_add_u32 v25, s59, v25
L_mx_poll:
    ds_read_b32 v26, v27 offset:3328
    ds_read_b128 v[64:67], v25
    ds_read_b128 v[68:71], v25 offset:1024
    s_waitcnt lgkmcnt(0)
    v_cmp_eq_u32 vcc, -1, v26
    s_cbranch_vccz L_mx_go
    s_sleep 16
    s_branch L_mx_poll
L_mx_go:
    v_lshlrev_b32 v72, 16, v64
    v_and_b32 v73, 0xffff0000, v64
    v_lshlrev_b32 v74, 16, v65
    v_and_b32 v75, 0xffff0000, v65
    v_lshlrev_b32 v76, 16, v66
    v_and_b32 v77, 0xffff0000, v66
    v_lshlrev_b32 v78, 16, v67
    v_and_b32 v79, 0xffff0000, v67
    v_lshlrev_b32 v80, 16, v68
    v_and_b32 v81, 0xffff0000, v68
    v_lshlrev_b32 v82, 16, v69
    v_and_b32 v83, 0xffff0000, v69
    v_lshlrev_b32 v84, 16, v70
    v_and_b32 v85, 0xffff0000, v70
    v_lshlrev_b32 v86, 16, v71
    v_and_b32 v87, 0xffff0000, v71
    v_sub_f32 v72, v72, v26
    v_sub_f32 v73, v73, v26
    v_sub_f32 v74, v74, v26
    v_sub_f32 v75, v75, v26
    v_sub_f32 v76, v76, v26
    v_sub_f32 v77, v77, v26
    v_sub_f32 v78, v78, v26
    v_sub_f32 v79, v79, v26
    v_sub_f32 v80, v80, v26
    v_sub_f32 v81, v81, v26
    v_sub_f32 v82, v82, v26
    v_sub_f32 v83, v83, v26
    v_sub_f32 v84, v84, v26
    v_sub_f32 v85, v85, v26
    v_sub_f32 v86, v86, v26
    v_sub_f32 v87, v87, v26
    v_mul_f32 v72, 0x3fb8aa3b, v72
    v_mul_f32 v73, 0x3fb8aa3b, v73
    v_mul_f32 v74, 0x3fb8aa3b, v74
    v_mul_f32 v75, 0x3fb8aa3b, v75
    v_mul_f32 v76, 0x3fb8aa3b, v76
    v_mul_f32 v77, 0x3fb8aa3b, v77
    v_mul_f32 v78, 0x3fb8aa3b, v78
    v_mul_f32 v79, 0x3fb8aa3b, v79
    v_mul_f32 v80, 0x3fb8aa3b, v80
    v_mul_f32 v81, 0x3fb8aa3b, v81
    v_mul_f32 v82, 0x3fb8aa3b, v82
    v_mul_f32 v83, 0x3fb8aa3b, v83
    v_mul_f32 v84, 0x3fb8aa3b, v84
    v_mul_f32 v85, 0x3fb8aa3b, v85
    v_mul_f32 v86, 0x3fb8aa3b, v86
    v_mul_f32 v87, 0x3fb8aa3b, v87
    v_exp_f32 v72, v72
    v_exp_f32 v73, v73
    v_exp_f32 v74, v74
    v_exp_f32 v75, v75
    v_exp_f32 v76, v76
    v_exp_f32 v77, v77
    v_exp_f32 v78, v78
    v_exp_f32 v79, v79
    v_exp_f32 v80, v80
    v_exp_f32 v81, v81
    v_exp_f32 v82, v82
    v_exp_f32 v83, v83
    v_exp_f32 v84, v84
    v_exp_f32 v85, v85
    v_exp_f32 v86, v86
    v_exp_f32 v87, v87
    v_add_f32 v72, v72, v80
    v_add_f32 v73, v73, v81
    v_add_f32 v74, v74, v82
    v_add_f32 v75, v75, v83
    v_add_f32 v76, v76, v84
    v_add_f32 v77, v77, v85
    v_add_f32 v78, v78, v86
    v_add_f32 v79, v79, v87
    v_add_f32 v72, v72, v76
    v_add_f32 v73, v73, v77
    v_add_f32 v74, v74, v78
    v_add_f32 v75, v75, v79
    v_add_f32 v72, v72, v74
    v_add_f32 v73, v73, v75
    v_add_f32 v72, v72, v73
    s_nop 1
    v_add_f32_dpp v72, v72, v72 quad_perm:[1,0,3,2] row_mask:0xf bank_mask:0xf
    s_nop 1
    v_add_f32_dpp v72, v72, v72 quad_perm:[2,3,0,1] row_mask:0xf bank_mask:0xf
    s_nop 1
    v_add_f32_dpp v72, v72, v72 row_half_mirror row_mask:0xf bank_mask:0xf
    s_nop 1
    v_add_f32_dpp v72, v72, v72 row_mirror row_mask:0xf bank_mask:0xf
    v_mov_b32 v24, v72
    s_nop 1
    v_permlane16_swap_b32 v24, v72
    s_nop 1
    v_add_f32 v72, v72, v24
    v_mov_b32 v24, v72
    s_nop 1
    v_permlane32_swap_b32 v24, v72
    s_nop 1
    v_add_f32 v72, v72, v24
    v_min_u32 v72, -2, v72
    ds_write_b32 v27, v72 offset:3344
L_nopre:
    s_cmp_lg_u32 s4, 2
    s_cbranch_scc1 L_nofb44
    v_mov_b32 v26, 0
    v_lshlrev_b32 v28, 24, v0
    s_and_b32 s58, s2, 7
    s_mul_i32 s54, s58, 48
    s_add_u32 s54, s54, s2
    s_and_b32 s54, s54, 0xff
    s_lshr_b32 s56, s54, 6
    s_mul_i32 s56, s56, 2048
    s_add_u32 s56, s56, 819200
    s_and_b32 s54, s54, 63
    s_add_u32 s36, s32, s56
    s_addc_u32 s37, s33, 0
L_fba2:
    s_sleep 1
    ds_read_b32 v24, v26 offset:3364
    s_waitcnt lgkmcnt(0)
    v_readfirstlane_b32 s58, v24
    s_cmp_lt_u32 s58, 282
    s_cbranch_scc1 L_fba2
    s_load_dword s80, s[36:37], 0 glc
    s_load_dword s81, s[36:37], 128 glc
    s_load_dword s82, s[36:37], 256 glc
    s_load_dword s83, s[36:37], 384 glc
    s_load_dword s84, s[36:37], 512 glc
    s_load_dword s85, s[36:37], 640 glc
    s_load_dword s86, s[36:37], 768 glc
    s_load_dword s87, s[36:37], 896 glc
    s_load_dword s88, s[36:37], 1024 glc
    s_load_dword s89, s[36:37], 1152 glc
    s_load_dword s90, s[36:37], 1280 glc
    s_load_dword s91, s[36:37], 1408 glc
    s_load_dword s92, s[36:37], 1536 glc
    s_load_dword s93, s[36:37], 1664 glc
    s_load_dword s94, s[36:37], 1792 glc
    s_load_dword s95, s[36:37], 1920 glc
    s_mov_b32 s58, 16
    s_waitcnt lgkmcnt(0)
    s_add_u32 s58, s58, s80
    s_add_u32 s58, s58, s81
    s_add_u32 s58, s58, s82
    s_add_u32 s58, s58, s83
    s_add_u32 s58, s58, s84
    s_add_u32 s58, s58, s85
    s_add_u32 s58, s58, s86
    s_add_u32 s58, s58, s87
    s_add_u32 s58, s58, s88
    s_add_u32 s58, s58, s89
    s_add_u32 s58, s58, s90
    s_add_u32 s58, s58, s91
    s_add_u32 s58, s58, s92
    s_add_u32 s58, s58, s93
    s_add_u32 s58, s58, s94
    s_add_u32 s58, s58, s95
    s_mov_b32 s60, s58
    s_mul_i32 s58, s58, 6
    s_ashr_i32 s58, s58, 2
    s_add_i32 s58, s58, 2
    s_cmp_eq_u32 s60, 0
    s_cselect_b32 s58, 0, s58
    s_max_i32 s58, s58, 0
    s_add_i32 s58, s58, s52
    s_min_i32 s58, s58, 32
    v_mov_b32 v25, s58
    ds_write_b32 v26, v25 offset:3368
    s_cmp_ge_u32 s60, 99
    s_cbranch_scc1 L_fbc2
    s_cmp_ge_u32 s54, 16
    s_cbranch_scc1 L_fbc2
    s_lshl_b32 s54, s54, 7
    s_add_u32 s54, s54, s56
L_fbb2:
    s_sleep 1
    ds_read_b32 v24, v26 offset:3364
    s_waitcnt lgkmcnt(0)
    v_readfirstlane_b32 s58, v24
    s_cmp_lt_u32 s58, 290
    s_cbranch_scc1 L_fbb2
    buffer_store_dword v26, v28, s[48:51], s54 offen sc1
L_fbc2:
    s_and_b32 s58, s2, 7
    s_mul_i32 s54, s58, 72
    s_add_u32 s54, s54, s2
    s_and_b32 s54, s54, 0xff
    s_lshr_b32 s56, s54, 6
    s_mul_i32 s56, s56, 2048
    s_add_u32 s56, s56, 827392
    s_and_b32 s54, s54, 63
    s_add_u32 s36, s32, s56
    s_addc_u32 s37, s33, 0
L_fba3:
    s_sleep 1
    ds_read_b32 v24, v26 offset:3364
    s_waitcnt lgkmcnt(0)
    v_readfirstlane_b32 s58, v24
    s_cmp_lt_u32 s58, 394
    s_cbranch_scc1 L_fba3
    s_load_dword s80, s[36:37], 0 glc
    s_load_dword s81, s[36:37], 128 glc
    s_load_dword s82, s[36:37], 256 glc
    s_load_dword s83, s[36:37], 384 glc
    s_load_dword s84, s[36:37], 512 glc
    s_load_dword s85, s[36:37], 640 glc
    s_load_dword s86, s[36:37], 768 glc
    s_load_dword s87, s[36:37], 896 glc
    s_load_dword s88, s[36:37], 1024 glc
    s_load_dword s89, s[36:37], 1152 glc
    s_load_dword s90, s[36:37], 1280 glc
    s_load_dword s91, s[36:37], 1408 glc
    s_load_dword s92, s[36:37], 1536 glc
    s_load_dword s93, s[36:37], 1664 glc
    s_load_dword s94, s[36:37], 1792 glc
    s_load_dword s95, s[36:37], 1920 glc
    s_mov_b32 s58, 16
    s_waitcnt lgkmcnt(0)
    s_add_u32 s58, s58, s80
    s_add_u32 s58, s58, s81
    s_add_u32 s58, s58, s82
    s_add_u32 s58, s58, s83
    s_add_u32 s58, s58, s84
    s_add_u32 s58, s58, s85
    s_add_u32 s58, s58, s86
    s_add_u32 s58, s58, s87
    s_add_u32 s58, s58, s88
    s_add_u32 s58, s58, s89
    s_add_u32 s58, s58, s90
    s_add_u32 s58, s58, s91
    s_add_u32 s58, s58, s92
    s_add_u32 s58, s58, s93
    s_add_u32 s58, s58, s94
    s_add_u32 s58, s58, s95
    s_mov_b32 s60, s58
    s_mul_i32 s58, s58, 10
    s_ashr_i32 s58, s58, 2
    s_add_i32 s58, s58, 4
    s_cmp_eq_u32 s60, 0
    s_cselect_b32 s58, 0, s58
    s_max_i32 s58, s58, 0
    s_add_i32 s58, s58, s52
    s_min_i32 s58, s58, 32
    v_mov_b32 v25, s58
    ds_write_b32 v26, v25 offset:3368
    s_cmp_ge_u32 s60, 99
    s_cbranch_scc1 L_fbc3
    s_cmp_ge_u32 s54, 16
    s_cbranch_scc1 L_fbc3
    s_lshl_b32 s54, s54, 7
    s_add_u32 s54, s54, s56
L_fbb3:
    s_sleep 1
    ds_read_b32 v24, v26 offset:3364
    s_waitcnt lgkmcnt(0)
    v_readfirstlane_b32 s58, v24
    s_cmp_lt_u32 s58, 402
    s_cbranch_scc1 L_fbb3
    buffer_store_dword v26, v28, s[48:51], s54 offen sc1
L_fbc3:
L_nofb44:
    v_and_b32 v3, 7, v0
    v_mul_u32_u24 v3, 160, v3
    v_lshl_add_u32 v3, v1, 4, v3
    v_mov_b32 v4, 0
    s_cmp_lg_u32 s4, 1
    s_cbranch_scc1 L_nowarm
    s_lshl_b32 s58, s2, 7
    s_add_u32 s58, s58, 737280
    buffer_load_dword v25, off, s[48:51], s58 sc1
    s_waitcnt vmcnt(0)
L_nowarm:
    s_mov_b32 s75, 1
    s_mov_b32 s50, 0
    s_mov_b32 s38, 0
    s_branch L_tail
L_real:
    s_waitcnt vmcnt(0)
    s_mov_b32 s75, 0
    s_mov_b32 s50, 835584
    s_mov_b32 s38, 1152
L_st_poll:
    ds_read_b128 v[84:87], v4 offset:3344
    ds_read_b128 v[80:83], v4 offset:3328
    s_waitcnt lgkmcnt(0)
    v_max_u32 v24, v84, v85
    v_max3_u32 v24, v24, v86, v87
    v_cmp_eq_u32 vcc, -1, v24
    s_cbranch_vccz L_st_go
    s_sleep 16
    s_branch L_st_poll
L_st_go:
    v_max_f32 v24, v80, v81
    v_max3_f32 v24, v24, v82, v83
    v_sub_f32 v80, v80, v24
    v_sub_f32 v81, v81, v24
    v_sub_f32 v82, v82, v24
    v_sub_f32 v83, v83, v24
    v_mul_f32 v80, 0x3fb8aa3b, v80
    v_mul_f32 v81, 0x3fb8aa3b, v81
    v_mul_f32 v82, 0x3fb8aa3b, v82
    v_mul_f32 v83, 0x3fb8aa3b, v83
    v_exp_f32 v80, v80
    v_exp_f32 v81, v81
    v_exp_f32 v82, v82
    v_exp_f32 v83, v83
    s_nop 0
    v_mul_f32 v24, v80, v84
    v_fmac_f32 v24, v81, v85
    v_fmac_f32 v24, v82, v86
    v_fmac_f32 v24, v83, v87
    v_rcp_f32 v24, v24
    s_nop 0
    v_mul_f32 v80, v80, v24
    v_mul_f32 v81, v81, v24
    v_mul_f32 v82, v82, v24
    v_mul_f32 v83, v83, v24
    v_bfe_u32 v84, v0, 2, 1
    v_mul_u32_u24 v84, 0xaaaa, v84
    v_add_u32 v84, 0x4444, v84
    v_mov_b32 v32, 0
    v_mov_b32 v33, 0
    v_mov_b32 v34, 0
    v_mov_b32 v35, 0
    v_mov_b32 v36, 0
    v_mov_b32 v37, 0
    v_mov_b32 v38, 0
    v_mov_b32 v39, 0
    v_mov_b32 v40, 0
    v_mov_b32 v41, 0
    v_mov_b32 v42, 0
    v_mov_b32 v43, 0
    v_mov_b32 v44, 0
    v_mov_b32 v45, 0
    v_mov_b32 v46, 0
    v_mov_b32 v47, 0
    v_mov_b32 v48, 0
    v_mov_b32 v49, 0
    v_mov_b32 v50, 0
    v_mov_b32 v51, 0
    v_mov_b32 v52, 0
    v_mov_b32 v53, 0
    v_mov_b32 v54, 0
    v_mov_b32 v55, 0
    v_mov_b32 v56, 0
    v_mov_b32 v57, 0
    v_mov_b32 v58, 0
    v_mov_b32 v59, 0
    v_mov_b32 v60, 0
    v_mov_b32 v61, 0
    v_mov_b32 v62, 0
    v_mov_b32 v63, 0
    v_mov_b32 v20, 0
    v_mov_b32 v21, 0
    v_mov_b32 v22, 0
    v_mov_b32 v23, 0
    s_mov_b32 vcc_lo, 0xffff0000
    s_mov_b32 vcc_hi, 0xffff0000
    s_setprio 3
    s_barrier
L_tail:
    ds_read_b128 v[64:67], v3 offset:2048
    ds_read_b128 v[68:71], v3 offset:2112
    buffer_store_dwordx4 v[96:99], v13, s[48:51], 0 offen sc1
    buffer_store_dwordx4 v[100:103], v13, s[48:51], 0 offen offset:2304 sc1
    s_waitcnt lgkmcnt(1)
    v_smfmac_f32_16x16x64_bf16 v[20:23], v[64:67], v[176:183], v84
    s_waitcnt lgkmcnt(0)
    v_smfmac_f32_16x16x64_bf16 v[20:23], v[68:71], v[248:255], v84
    s_nop 1
    v_smfmac_f32_16x16x64_bf16 v[32:35], v[64:67], v[112:119], v84
    s_nop 1
    v_smfmac_f32_16x16x64_bf16 v[32:35], v[68:71], v[184:191], v84
    s_nop 1
    v_smfmac_f32_16x16x64_bf16 v[48:51], v[64:67], v[144:151], v84
    v_mul_f32 v20, v20, v80
    v_fmac_f32 v20, v21, v81
    v_fmac_f32 v20, v22, v82
    v_smfmac_f32_16x16x64_bf16 v[48:51], v[68:71], v[216:223], v84
    v_fmac_f32 v20, v23, v83
    v_mov_b32 v21, v20
    v_mul_f32 v88, v32, v80
    v_smfmac_f32_16x16x64_bf16 v[36:39], v[64:67], v[120:127], v84
    v_permlane16_swap_b32 v20, v21
    v_fmac_f32 v88, v33, v81
    v_add_f32 v20, v20, v21
    v_smfmac_f32_16x16x64_bf16 v[36:39], v[68:71], v[192:199], v84
    v_min_u32 v20, -2, v20
    buffer_store_dword v20, v6, s[48:51], 0 offen sc1
    v_fmac_f32 v88, v34, v82
    v_smfmac_f32_16x16x64_bf16 v[52:55], v[64:67], v[152:159], v84
    v_fmac_f32 v88, v35, v83
    v_mul_f32 v48, v48, v80
    v_fmac_f32 v48, v49, v81
    v_smfmac_f32_16x16x64_bf16 v[52:55], v[68:71], v[224:231], v84
    v_fmac_f32 v48, v50, v82
    v_fmac_f32 v48, v51, v83
    v_mul_f32 v89, v36, v80
    v_smfmac_f32_16x16x64_bf16 v[40:43], v[64:67], v[128:135], v84
    v_permlane16_swap_b32 v88, v48
    v_fmac_f32 v89, v37, v81
    v_add_f32 v88, v88, v48
    v_smfmac_f32_16x16x64_bf16 v[40:43], v[68:71], v[200:207], v84
    v_min_u32 v88, -2, v88
    v_fmac_f32 v89, v38, v82
    v_fmac_f32 v89, v39, v83
    v_smfmac_f32_16x16x64_bf16 v[56:59], v[64:67], v[160:167], v84
    v_mul_f32 v52, v52, v80
    v_fmac_f32 v52, v53, v81
    v_fmac_f32 v52, v54, v82
    v_smfmac_f32_16x16x64_bf16 v[56:59], v[68:71], v[232:239], v84
    v_fmac_f32 v52, v55, v83
    v_mul_f32 v90, v40, v80
    v_fmac_f32 v90, v41, v81
    v_smfmac_f32_16x16x64_bf16 v[44:47], v[64:67], v[136:143], v84
    v_permlane16_swap_b32 v89, v52
    v_fmac_f32 v90, v42, v82
    v_add_f32 v89, v89, v52
    v_smfmac_f32_16x16x64_bf16 v[44:47], v[68:71], v[208:215], v84
    v_min_u32 v89, -2, v89
    v_fmac_f32 v90, v43, v83
    v_mul_f32 v56, v56, v80
    v_smfmac_f32_16x16x64_bf16 v[60:63], v[64:67], v[168:175], v84
    v_fmac_f32 v56, v57, v81
    v_fmac_f32 v56, v58, v82
    v_fmac_f32 v56, v59, v83
    v_smfmac_f32_16x16x64_bf16 v[60:63], v[68:71], v[240:247], v84
    v_mul_f32 v91, v44, v80
    v_permlane16_swap_b32 v90, v56
    v_fmac_f32 v91, v45, v81
    v_add_f32 v90, v90, v56
    v_min_u32 v90, -2, v90
    v_fmac_f32 v91, v46, v82
    v_fmac_f32 v91, v47, v83
    s_nop 0
    v_mul_f32 v60, v60, v80
    v_fmac_f32 v60, v61, v81
    v_fmac_f32 v60, v62, v82
    v_fmac_f32 v60, v63, v83
    s_nop 1
    v_permlane16_swap_b32 v91, v60
    s_nop 0
    v_add_f32 v91, v91, v60
    v_min_u32 v91, -2, v91
    buffer_store_dwordx4 v[88:91], v5, s[48:51], 0 offen sc1
L_hend:
    s_cmp_eq_u32 s75, 1
    s_cbranch_scc1 L_real
    s_barrier
    s_endpgm
L_exit:
    s_endpgm
.section .rodata,"a"
.p2align 6
.amdhsa_kernel recurrent_scan__mha_block_cached__dense_activation_gelu__decode_kernel
  .amdhsa_next_free_vgpr 256
  .amdhsa_next_free_sgpr 96
  .amdhsa_accum_offset 256
  .amdhsa_group_segment_fixed_size 0
  .amdhsa_kernarg_size 104
  .amdhsa_user_sgpr_count 2
  .amdhsa_user_sgpr_kernarg_segment_ptr 1
  .amdhsa_system_sgpr_workgroup_id_x 1
  .amdhsa_float_denorm_mode_32 3
.end_amdhsa_kernel
```
